```python
import torch

def _softmax(x, axis=-1):
    return torch.softmax(x, dim=axis)
def _gelu(x):
    return torch.nn.functional.gelu(x, approximate="tanh")
def _silu(x):
    return torch.nn.functional.silu(x)
def _sigmoid(x):
    return torch.sigmoid(x)
def _layernorm(x, axis=-1, eps=1e-5):
    m = x.mean(dim=axis, keepdim=True)
    v = x.var(dim=axis, keepdim=True, unbiased=False)
    return (x - m) / torch.sqrt(v + eps)
def _scatter_add(tgt, idx, src, axis=0):
    return tgt.clone().index_add_(axis, idx, src)
def _segment_sum(src, seg, n):
    out = torch.zeros((n,) + src.shape[1:], dtype=src.dtype)
    return out.index_add_(0, seg, src)
def _pad(x, pw):
    flat = tuple(v for pair in reversed(pw) for v in pair)
    return torch.nn.functional.pad(x, flat)

kernel_name = 'gated_mix__spectral_gfnet__dense_activation_gelu__prompt'

def setup_inputs():

    _w = (lambda a: (lambda t: t.to(torch.bfloat16) if t.is_floating_point() else t)(torch.as_tensor(a)))
    def _A_setup():
        B, S, D = 1, 2048, 512
        Df = D // 2 + 1
        return {
            "x": _w((lambda *s: torch.randn(*s, dtype=torch.bfloat16) * 0.05)(B, S, D)),
            "w_r": _w((lambda *s: torch.randn(*s, dtype=torch.bfloat16) * 1.6)(S, Df) * 0.02),
            "w_i": _w((lambda *s: torch.randn(*s, dtype=torch.bfloat16) * 1.6)(S, Df) * 0.02),
        }
    _A_in = _A_setup()

    def _B_setup():
        B, S, D, F = 1, 2048, 512, 1376
        return {
            "x": _w((lambda *s: torch.randn(*s, dtype=torch.bfloat16) * 0.05)(B, S, D)),
            "w1": _w((lambda *s: torch.randn(*s, dtype=torch.bfloat16) * 3.2)(D, F) * (D ** -0.5)),
            "b1": _w((lambda *s: torch.randn(*s, dtype=torch.bfloat16) * 3.2)(F) * 0.01),
            "w2": _w((lambda *s: torch.randn(*s, dtype=torch.bfloat16) * 0.05)(F, D) * (F ** -0.5)),
            "b2": _w((lambda *s: torch.randn(*s, dtype=torch.bfloat16) * 0.1)(D) * 0.01),
        }
    _B_in = _B_setup()

    return {
        "A_x": _A_in["x"],
        "A_w_r": _A_in["w_r"],
        "A_w_i": _A_in["w_i"],
        "B_x": _B_in["x"],
        "B_w1": _B_in["w1"],
        "B_b1": _B_in["b1"],
        "B_w2": _B_in["w2"],
        "B_b2": _B_in["b2"],
        "gate_w": _w((lambda *s: torch.randn(*s, dtype=torch.bfloat16) * 0.05)(512) * 16.0),
    }

def reference(A_x, A_w_r, A_w_i, B_x, B_w1, B_b1, B_w2, B_b2, gate_w):
    def _A_ref(x, w_r, w_i):
        B, S, D = x.shape
        X = (lambda x, axes=(-2,-1): torch.fft.rfft2(x.float(), dim=axes))(x, axes=(-2, -1))
        W = w_r + 1j * w_i
        X = X * W
        y = (lambda x, s, axes=(-2,-1): torch.fft.irfft2(x, s=s, dim=axes).to(torch.bfloat16))(X, (S, D), axes=(-2, -1))
        return y

    def _B_ref(x, w1, b1, w2, b2):
        h = torch.einsum("bsd,df->bsf", x, w1) + b1
        h = _gelu(h)
        return torch.einsum("bsf,fd->bsd", h, w2) + b2

    x = A_x
    g = _sigmoid((x * gate_w).sum(-1, keepdims=True))
    a = _A_ref(x, A_w_r, A_w_i)
    b = _B_ref(x, B_w1, B_b1, B_w2, B_b2)
    return g * a + (1 - g) * b
```

```asm
; @launch grid=(256,1,1) block=(512,1,1) lds=163840
.amdgcn_target "amdgcn-amd-amdhsa--gfx950"
.text
.globl gated_mix__spectral_gfnet__dense_activation_gelu__prompt_kernel
.p2align 8
.type gated_mix__spectral_gfnet__dense_activation_gelu__prompt_kernel,@function
gated_mix__spectral_gfnet__dense_activation_gelu__prompt_kernel:
    s_cmp_ge_u32 s2, 256
    s_cbranch_scc1 L_end
    s_load_dwordx4 s[4:7], s[0:1], 0
    s_load_dwordx2 s[8:9], s[0:1], 16
    s_load_dwordx8 s[12:19], s[0:1], 32
    s_load_dwordx8 s[20:27], s[0:1], 64
    v_lshrrev_b32 v1, 6, v0
    v_and_b32 v0, 63, v0
    v_readfirstlane_b32 s3, v1
    s_and_b32 s72, s2, 7
    s_lshr_b32 s73, s2, 3
    s_add_u32 s76, s73, 0
    s_and_b32 s76, s76, 7
    s_cmp_eq_u32 s73, 27
    s_cselect_b32 s76, 6, s76
    s_cmp_eq_u32 s73, 30
    s_cselect_b32 s76, 3, s76
    s_lshr_b32 s74, s73, 3
    s_lshl_b32 s75, s72, 2
    s_add_u32 s75, s75, s74
    s_lshr_b32 s74, s75, 1
    s_and_b32 s75, s75, 1
    s_and_b32 s64, s3, 1
    s_lshr_b32 s65, s3, 1
    v_lshrrev_b32 v232, 3, v0
    v_bfe_u32 v233, v0, 4, 1
    v_lshlrev_b32 v233, 2, v233
    v_and_b32 v234, 7, v0
    v_xor_b32 v233, v233, v234
    v_lshlrev_b32 v233, 4, v233
    v_lshl_add_u32 v240, v232, 10, v233
    s_mul_i32 s66, s65, 352
    s_lshl_b32 s67, s64, 4
    s_add_u32 s66, s66, s67
    s_lshl_b32 s66, s66, 10
    s_lshl_b32 s67, s76, 7
    s_add_u32 s66, s66, s67
    s_lshl_b32 s68, s65, 12
    s_lshl_b32 s67, s64, 11
    s_add_u32 s68, s68, s67
    s_cmp_ge_u32 s73, 22
    s_cbranch_scc1 L_notg1
    s_and_b32 s70, s73, 1
    s_lshl_b32 s71, s72, 1
    s_add_u32 s70, s70, s71
    s_lshr_b32 s71, s73, 1
    s_lshl_b32 s50, s3, 1
    v_lshrrev_b32 v24, 3, v0
    s_add_u32 s51, s50, 0
    s_lshl_b32 s51, s51, 3
    v_add_u32 v24, s51, v24
    v_lshlrev_b32 v24, 14, v24
    v_lshrrev_b32 v25, 4, v0
    v_and_b32 v26, 7, v0
    v_xor_b32 v25, v25, v26
    v_lshl_add_u32 v24, v25, 4, v24
    s_lshl_b32 s51, s70, 10
    v_add_u32 v2, s51, v24
    v_lshrrev_b32 v24, 3, v0
    s_add_u32 s51, s50, 1
    s_lshl_b32 s51, s51, 3
    v_add_u32 v24, s51, v24
    v_lshlrev_b32 v24, 14, v24
    v_lshrrev_b32 v25, 4, v0
    v_add_u32 v25, 4, v25
    v_and_b32 v26, 7, v0
    v_xor_b32 v25, v25, v26
    v_lshl_add_u32 v24, v25, 4, v24
    s_lshl_b32 s51, s70, 10
    v_add_u32 v3, s51, v24
    v_lshrrev_b32 v24, 4, v0
    v_lshlrev_b32 v25, 2, v24
    v_and_b32 v26, 15, v0
    v_xor_b32 v25, v25, v26
    v_lshlrev_b32 v25, 4, v25
    s_lshl_b32 s52, s71, 8
    v_add_u32 v25, s52, v25
    v_min_u32 v25, 2736, v25
    s_add_u32 s51, s50, 0
    s_lshl_b32 s51, s51, 2
    v_add_u32 v27, s51, v24
    v_mul_u32_u24 v27, 2752, v27
    v_add_u32 v4, v27, v25
    s_add_u32 s51, s50, 1
    s_lshl_b32 s51, s51, 2
    v_add_u32 v27, s51, v24
    v_mul_u32_u24 v27, 2752, v27
    v_add_u32 v5, v27, v25
    s_lshl_b32 s48, s3, 11
    s_add_u32 s49, s48, 16384
    s_and_b32 s59, s70, 1
    s_lshl_b32 s59, s59, 2
    s_add_u32 s59, s59, s72
    s_lshr_b32 s54, s3, 2
    s_lshl_b32 s55, s54, 7
    s_lshl_b32 s52, s71, 8
    s_add_u32 s55, s55, s52
    v_lshl_add_u32 v31, v0, 1, s55
    v_cmp_gt_u32 vcc, 32, v0
    v_mov_b32 v30, 0x10000
    s_nop 0
    v_cndmask_b32 v31, v30, v31, vcc
    v_mov_b32 v30, 0x3f80
    v_cndmask_b32 v120, 0, v30, vcc
    v_mov_b32 v113, 0
    v_mov_b32 v114, 0
    v_mov_b32 v115, 0
    v_mov_b32 v117, 0
    v_mov_b32 v118, 0
    v_mov_b32 v119, 0
    v_mov_b32 v121, 0
    v_mov_b32 v122, 0
    v_mov_b32 v123, 0
    s_waitcnt lgkmcnt(0)
    s_mov_b32 s28, s26
    s_and_b32 s29, s27, 0xffff
    s_mov_b32 s30, 0x1000000
    s_mov_b32 s31, 0x20000
    s_mov_b32 s32, s4
    s_and_b32 s33, s5, 0xffff
    s_mov_b32 s34, 0x200000
    s_mov_b32 s35, 0x20000
    s_mov_b32 s36, s12
    s_and_b32 s37, s13, 0xffff
    s_mov_b32 s38, 0x158000
    s_mov_b32 s39, 0x20000
    s_add_u32 s52, s59, 0
    s_and_b32 s52, s52, 7
    s_lshl_b32 s53, s52, 7
    s_add_u32 m0, s48, 0
    s_nop 0
    buffer_load_dwordx4 v2, s[32:35], s53 offen lds
    s_add_u32 m0, s48, 1024
    s_nop 0
    buffer_load_dwordx4 v3, s[32:35], s53 offen lds
    s_add_u32 s52, s59, 0
    s_and_b32 s52, s52, 7
    s_mul_i32 s53, s52, 176128
    s_add_u32 m0, s49, 0
    s_nop 0
    buffer_load_dwordx4 v4, s[36:39], s53 offen lds
    s_add_u32 m0, s49, 1024
    s_nop 0
    buffer_load_dwordx4 v5, s[36:39], s53 offen lds
    s_barrier
    s_add_u32 s52, s59, 1
    s_and_b32 s52, s52, 7
    s_lshl_b32 s53, s52, 7
    s_add_u32 m0, s48, 32768
    s_nop 0
    buffer_load_dwordx4 v2, s[32:35], s53 offen lds
    s_add_u32 m0, s48, 33792
    s_nop 0
    buffer_load_dwordx4 v3, s[32:35], s53 offen lds
    s_add_u32 s52, s59, 1
    s_and_b32 s52, s52, 7
    s_mul_i32 s53, s52, 176128
    s_add_u32 m0, s49, 32768
    s_nop 0
    buffer_load_dwordx4 v4, s[36:39], s53 offen lds
    s_add_u32 m0, s49, 33792
    s_nop 0
    buffer_load_dwordx4 v5, s[36:39], s53 offen lds
    s_mov_b32 s40, s16
    s_and_b32 s41, s17, 0xffff
    s_mov_b32 s42, 0x158000
    s_mov_b32 s43, 0x20000
    s_mov_b32 s96, s24
    s_and_b32 s97, s25, 0xffff
    s_mov_b32 s98, 0x100
    s_mov_b32 s99, 0x20000
    s_or_b32 s100, s2, s3
    s_cmp_lg_u32 s100, 0
    s_cbranch_scc1 npub_1
    s_memrealtime s[78:79]
    s_waitcnt lgkmcnt(0)
    s_or_b32 s78, s78, 1
    v_mov_b32 v250, s78
    v_mov_b32 v251, s79
    v_mov_b32 v248, 0
    s_mov_b64 exec, 1
    buffer_store_dwordx2 v[250:251], v248, s[96:99], 0 offen sc1
    s_mov_b64 exec, -1
npub_1:
    s_and_b32 s56, s3, 3
    s_lshl_b32 s57, s56, 12
    v_and_b32 v24, 31, v0
    v_lshrrev_b32 v25, 1, v24
    v_and_b32 v25, 7, v25
    v_lshrrev_b32 v26, 5, v0
    v_xor_b32 v25, v25, v26
    v_lshlrev_b32 v24, 7, v24
    v_add_u32 v24, s57, v24
    v_xor_b32 v26, 0, v25
    v_lshl_add_u32 v6, v26, 4, v24
    v_add_u32 v10, 0x10000, v6
    v_add_u32 v14, 0x20000, v6
    v_xor_b32 v26, 2, v25
    v_lshl_add_u32 v7, v26, 4, v24
    v_add_u32 v11, 0x10000, v7
    v_add_u32 v15, 0x20000, v7
    v_xor_b32 v26, 4, v25
    v_lshl_add_u32 v8, v26, 4, v24
    v_add_u32 v12, 0x10000, v8
    v_add_u32 v16, 0x20000, v8
    v_xor_b32 v26, 6, v25
    v_lshl_add_u32 v9, v26, 4, v24
    v_add_u32 v13, 0x10000, v9
    v_add_u32 v17, 0x20000, v9
    v_bfe_u32 v24, v0, 2, 2
    v_lshrrev_b32 v25, 5, v0
    v_lshl_add_u32 v25, v25, 3, v24
    v_lshlrev_b32 v25, 8, v25
    v_bfe_u32 v26, v0, 4, 1
    v_bfe_u32 v27, v0, 1, 1
    v_lshl_add_u32 v26, v26, 1, v27
    v_and_b32 v27, 1, v0
    v_lshlrev_b32 v27, 3, v27
    v_add3_u32 v25, v25, v27, 0
    v_add_u32 v25, 16384, v25
    s_lshl_b32 s58, s54, 1
    s_add_u32 s58, s58, 0
    v_xor_b32 v28, s58, v24
    v_lshl_add_u32 v28, v28, 2, v26
    v_lshl_add_u32 v18, v28, 4, v25
    v_add_u32 v20, 0x10000, v18
    v_add_u32 v22, 0x20000, v18
    s_lshl_b32 s58, s54, 1
    s_add_u32 s58, s58, 1
    v_xor_b32 v28, s58, v24
    v_lshl_add_u32 v28, v28, 2, v26
    v_lshl_add_u32 v19, v28, 4, v25
    v_add_u32 v21, 0x10000, v19
    v_add_u32 v23, 0x20000, v19
    s_mov_b32 s44, s14
    s_and_b32 s45, s15, 0xffff
    s_mov_b32 s46, 0xac0
    s_mov_b32 s47, 0x20000
    buffer_load_ushort v112, v31, s[44:47], 0 offen offset:0
    buffer_load_ushort v116, v31, s[44:47], 0 offen offset:64
    s_waitcnt vmcnt(6)
    s_barrier
    ds_read_b128 v[32:35], v6 offset:0
    ds_read_b64_tr_b16 v[48:49], v18 offset:0
    ds_read_b64_tr_b16 v[50:51], v18 offset:1024
    ds_read_b64_tr_b16 v[64:65], v19 offset:0
    ds_read_b64_tr_b16 v[66:67], v19 offset:1024
    ds_read_b128 v[36:39], v7 offset:0
    ds_read_b64_tr_b16 v[52:53], v18 offset:4096
    ds_read_b64_tr_b16 v[54:55], v18 offset:5120
    ds_read_b64_tr_b16 v[68:69], v19 offset:4096
    ds_read_b64_tr_b16 v[70:71], v19 offset:5120
    s_add_u32 s52, s59, 2
    s_and_b32 s52, s52, 7
    s_lshl_b32 s53, s52, 7
    s_add_u32 m0, s48, 65536
    s_nop 0
    buffer_load_dwordx4 v2, s[32:35], s53 offen lds
    s_add_u32 m0, s48, 66560
    s_nop 0
    buffer_load_dwordx4 v3, s[32:35], s53 offen lds
    s_add_u32 s52, s59, 2
    s_and_b32 s52, s52, 7
    s_mul_i32 s53, s52, 176128
    s_add_u32 m0, s49, 65536
    s_nop 0
    buffer_load_dwordx4 v4, s[36:39], s53 offen lds
    s_add_u32 m0, s49, 66560
    s_nop 0
    buffer_load_dwordx4 v5, s[36:39], s53 offen lds
    s_waitcnt lgkmcnt(5)
    v_mfma_f32_32x32x16_bf16 v[80:95], v[48:51], v[32:35], 0
    ds_read_b128 v[40:43], v8 offset:0
    ds_read_b64_tr_b16 v[56:57], v18 offset:8192
    ds_read_b64_tr_b16 v[58:59], v18 offset:9216
    ds_read_b64_tr_b16 v[72:73], v19 offset:8192
    ds_read_b64_tr_b16 v[74:75], v19 offset:9216
    v_mfma_f32_32x32x16_bf16 v[96:111], v[64:67], v[32:35], 0
    s_waitcnt lgkmcnt(5)
    v_mfma_f32_32x32x16_bf16 v[80:95], v[52:55], v[36:39], v[80:95]
    ds_read_b128 v[44:47], v9 offset:0
    ds_read_b64_tr_b16 v[60:61], v18 offset:12288
    ds_read_b64_tr_b16 v[62:63], v18 offset:13312
    ds_read_b64_tr_b16 v[76:77], v19 offset:12288
    ds_read_b64_tr_b16 v[78:79], v19 offset:13312
    v_mfma_f32_32x32x16_bf16 v[96:111], v[68:71], v[36:39], v[96:111]
    s_waitcnt lgkmcnt(5)
    v_mfma_f32_32x32x16_bf16 v[80:95], v[56:59], v[40:43], v[80:95]
    v_mfma_f32_32x32x16_bf16 v[96:111], v[72:75], v[40:43], v[96:111]
    s_waitcnt lgkmcnt(0)
    s_waitcnt vmcnt(6)
    s_barrier
    v_mfma_f32_32x32x16_bf16 v[80:95], v[60:63], v[44:47], v[80:95]
    ds_read_b128 v[32:35], v6 offset:32768
    ds_read_b64_tr_b16 v[48:49], v18 offset:32768
    ds_read_b64_tr_b16 v[50:51], v18 offset:33792
    ds_read_b64_tr_b16 v[64:65], v19 offset:32768
    ds_read_b64_tr_b16 v[66:67], v19 offset:33792
    v_mfma_f32_32x32x16_bf16 v[96:111], v[76:79], v[44:47], v[96:111]
    ds_read_b128 v[36:39], v7 offset:32768
    ds_read_b64_tr_b16 v[52:53], v18 offset:36864
    ds_read_b64_tr_b16 v[54:55], v18 offset:37888
    ds_read_b64_tr_b16 v[68:69], v19 offset:36864
    ds_read_b64_tr_b16 v[70:71], v19 offset:37888
    s_add_u32 s52, s59, 3
    s_and_b32 s52, s52, 7
    s_lshl_b32 s53, s52, 7
    s_add_u32 m0, s48, 98304
    s_nop 0
    buffer_load_dwordx4 v2, s[32:35], s53 offen lds
    s_waitcnt lgkmcnt(5)
    v_mfma_f32_32x32x16_bf16 v[80:95], v[48:51], v[32:35], v[80:95]
    ds_read_b128 v[40:43], v8 offset:32768
    ds_read_b64_tr_b16 v[56:57], v18 offset:40960
    ds_read_b64_tr_b16 v[58:59], v18 offset:41984
    ds_read_b64_tr_b16 v[72:73], v19 offset:40960
    ds_read_b64_tr_b16 v[74:75], v19 offset:41984
    v_mfma_f32_32x32x16_bf16 v[96:111], v[64:67], v[32:35], v[96:111]
    s_add_u32 m0, s48, 99328
    s_nop 0
    buffer_load_dwordx4 v3, s[32:35], s53 offen lds
    s_waitcnt lgkmcnt(5)
    v_mfma_f32_32x32x16_bf16 v[80:95], v[52:55], v[36:39], v[80:95]
    ds_read_b128 v[44:47], v9 offset:32768
    ds_read_b64_tr_b16 v[60:61], v18 offset:45056
    ds_read_b64_tr_b16 v[62:63], v18 offset:46080
    ds_read_b64_tr_b16 v[76:77], v19 offset:45056
    ds_read_b64_tr_b16 v[78:79], v19 offset:46080
    v_mfma_f32_32x32x16_bf16 v[96:111], v[68:71], v[36:39], v[96:111]
    s_add_u32 s52, s59, 3
    s_and_b32 s52, s52, 7
    s_mul_i32 s53, s52, 176128
    s_add_u32 m0, s49, 98304
    s_nop 0
    buffer_load_dwordx4 v4, s[36:39], s53 offen lds
    s_waitcnt lgkmcnt(5)
    v_mfma_f32_32x32x16_bf16 v[80:95], v[56:59], v[40:43], v[80:95]
    v_mfma_f32_32x32x16_bf16 v[96:111], v[72:75], v[40:43], v[96:111]
    s_add_u32 m0, s49, 99328
    s_nop 0
    buffer_load_dwordx4 v5, s[36:39], s53 offen lds
    s_waitcnt lgkmcnt(0)
    s_waitcnt vmcnt(4)
    s_barrier
    v_mfma_f32_32x32x16_bf16 v[80:95], v[112:115], v[120:123], v[80:95]
    v_mfma_f32_32x32x16_bf16 v[96:111], v[116:119], v[120:123], v[96:111]
    v_mfma_f32_32x32x16_bf16 v[80:95], v[60:63], v[44:47], v[80:95]
    ds_read_b128 v[32:35], v10 offset:0
    ds_read_b64_tr_b16 v[48:49], v20 offset:0
    ds_read_b64_tr_b16 v[50:51], v20 offset:1024
    ds_read_b64_tr_b16 v[64:65], v21 offset:0
    ds_read_b64_tr_b16 v[66:67], v21 offset:1024
    v_mfma_f32_32x32x16_bf16 v[96:111], v[76:79], v[44:47], v[96:111]
    ds_read_b128 v[36:39], v11 offset:0
    ds_read_b64_tr_b16 v[52:53], v20 offset:4096
    ds_read_b64_tr_b16 v[54:55], v20 offset:5120
    ds_read_b64_tr_b16 v[68:69], v21 offset:4096
    ds_read_b64_tr_b16 v[70:71], v21 offset:5120
    s_add_u32 s52, s59, 4
    s_and_b32 s52, s52, 7
    s_lshl_b32 s53, s52, 7
    s_add_u32 m0, s48, 131072
    s_nop 0
    buffer_load_dwordx4 v2, s[32:35], s53 offen lds
    s_waitcnt lgkmcnt(5)
    v_mfma_f32_32x32x16_bf16 v[80:95], v[48:51], v[32:35], v[80:95]
    ds_read_b128 v[40:43], v12 offset:0
    ds_read_b64_tr_b16 v[56:57], v20 offset:8192
    ds_read_b64_tr_b16 v[58:59], v20 offset:9216
    ds_read_b64_tr_b16 v[72:73], v21 offset:8192
    ds_read_b64_tr_b16 v[74:75], v21 offset:9216
    v_mfma_f32_32x32x16_bf16 v[96:111], v[64:67], v[32:35], v[96:111]
    s_add_u32 m0, s48, 132096
    s_nop 0
    buffer_load_dwordx4 v3, s[32:35], s53 offen lds
    s_waitcnt lgkmcnt(5)
    v_mfma_f32_32x32x16_bf16 v[80:95], v[52:55], v[36:39], v[80:95]
    ds_read_b128 v[44:47], v13 offset:0
    ds_read_b64_tr_b16 v[60:61], v20 offset:12288
    ds_read_b64_tr_b16 v[62:63], v20 offset:13312
    ds_read_b64_tr_b16 v[76:77], v21 offset:12288
    ds_read_b64_tr_b16 v[78:79], v21 offset:13312
    v_mfma_f32_32x32x16_bf16 v[96:111], v[68:71], v[36:39], v[96:111]
    s_add_u32 s52, s59, 4
    s_and_b32 s52, s52, 7
    s_mul_i32 s53, s52, 176128
    s_add_u32 m0, s49, 131072
    s_nop 0
    buffer_load_dwordx4 v4, s[36:39], s53 offen lds
    s_waitcnt lgkmcnt(5)
    v_mfma_f32_32x32x16_bf16 v[80:95], v[56:59], v[40:43], v[80:95]
    v_mfma_f32_32x32x16_bf16 v[96:111], v[72:75], v[40:43], v[96:111]
    s_add_u32 m0, s49, 132096
    s_nop 0
    buffer_load_dwordx4 v5, s[36:39], s53 offen lds
    s_waitcnt lgkmcnt(0)
    s_waitcnt vmcnt(4)
    s_barrier
    v_mfma_f32_32x32x16_bf16 v[80:95], v[60:63], v[44:47], v[80:95]
    ds_read_b128 v[32:35], v10 offset:32768
    ds_read_b64_tr_b16 v[48:49], v20 offset:32768
    ds_read_b64_tr_b16 v[50:51], v20 offset:33792
    ds_read_b64_tr_b16 v[64:65], v21 offset:32768
    ds_read_b64_tr_b16 v[66:67], v21 offset:33792
    v_mfma_f32_32x32x16_bf16 v[96:111], v[76:79], v[44:47], v[96:111]
    ds_read_b128 v[36:39], v11 offset:32768
    ds_read_b64_tr_b16 v[52:53], v20 offset:36864
    ds_read_b64_tr_b16 v[54:55], v20 offset:37888
    ds_read_b64_tr_b16 v[68:69], v21 offset:36864
    ds_read_b64_tr_b16 v[70:71], v21 offset:37888
    s_add_u32 s52, s59, 5
    s_and_b32 s52, s52, 7
    s_lshl_b32 s53, s52, 7
    s_add_u32 m0, s48, 0
    s_nop 0
    buffer_load_dwordx4 v2, s[32:35], s53 offen lds
    s_waitcnt lgkmcnt(5)
    v_mfma_f32_32x32x16_bf16 v[80:95], v[48:51], v[32:35], v[80:95]
    ds_read_b128 v[40:43], v12 offset:32768
    ds_read_b64_tr_b16 v[56:57], v20 offset:40960
    ds_read_b64_tr_b16 v[58:59], v20 offset:41984
    ds_read_b64_tr_b16 v[72:73], v21 offset:40960
    ds_read_b64_tr_b16 v[74:75], v21 offset:41984
    v_mfma_f32_32x32x16_bf16 v[96:111], v[64:67], v[32:35], v[96:111]
    s_add_u32 m0, s48, 1024
    s_nop 0
    buffer_load_dwordx4 v3, s[32:35], s53 offen lds
    s_waitcnt lgkmcnt(5)
    v_mfma_f32_32x32x16_bf16 v[80:95], v[52:55], v[36:39], v[80:95]
    ds_read_b128 v[44:47], v13 offset:32768
    ds_read_b64_tr_b16 v[60:61], v20 offset:45056
    ds_read_b64_tr_b16 v[62:63], v20 offset:46080
    ds_read_b64_tr_b16 v[76:77], v21 offset:45056
    ds_read_b64_tr_b16 v[78:79], v21 offset:46080
    v_mfma_f32_32x32x16_bf16 v[96:111], v[68:71], v[36:39], v[96:111]
    s_add_u32 s52, s59, 5
    s_and_b32 s52, s52, 7
    s_mul_i32 s53, s52, 176128
    s_add_u32 m0, s49, 0
    s_nop 0
    buffer_load_dwordx4 v4, s[36:39], s53 offen lds
    s_waitcnt lgkmcnt(5)
    v_mfma_f32_32x32x16_bf16 v[80:95], v[56:59], v[40:43], v[80:95]
    v_mfma_f32_32x32x16_bf16 v[96:111], v[72:75], v[40:43], v[96:111]
    s_add_u32 m0, s49, 1024
    s_nop 0
    buffer_load_dwordx4 v5, s[36:39], s53 offen lds
    s_waitcnt lgkmcnt(0)
    s_waitcnt vmcnt(4)
    s_barrier
    v_mfma_f32_32x32x16_bf16 v[80:95], v[60:63], v[44:47], v[80:95]
    ds_read_b128 v[32:35], v14 offset:0
    ds_read_b64_tr_b16 v[48:49], v22 offset:0
    ds_read_b64_tr_b16 v[50:51], v22 offset:1024
    ds_read_b64_tr_b16 v[64:65], v23 offset:0
    ds_read_b64_tr_b16 v[66:67], v23 offset:1024
    v_mfma_f32_32x32x16_bf16 v[96:111], v[76:79], v[44:47], v[96:111]
    ds_read_b128 v[36:39], v15 offset:0
    ds_read_b64_tr_b16 v[52:53], v22 offset:4096
    ds_read_b64_tr_b16 v[54:55], v22 offset:5120
    ds_read_b64_tr_b16 v[68:69], v23 offset:4096
    ds_read_b64_tr_b16 v[70:71], v23 offset:5120
    s_add_u32 s52, s59, 6
    s_and_b32 s52, s52, 7
    s_lshl_b32 s53, s52, 7
    s_add_u32 m0, s48, 32768
    s_nop 0
    buffer_load_dwordx4 v2, s[32:35], s53 offen lds
    s_waitcnt lgkmcnt(5)
    v_mfma_f32_32x32x16_bf16 v[80:95], v[48:51], v[32:35], v[80:95]
    ds_read_b128 v[40:43], v16 offset:0
    ds_read_b64_tr_b16 v[56:57], v22 offset:8192
    ds_read_b64_tr_b16 v[58:59], v22 offset:9216
    ds_read_b64_tr_b16 v[72:73], v23 offset:8192
    ds_read_b64_tr_b16 v[74:75], v23 offset:9216
    v_mfma_f32_32x32x16_bf16 v[96:111], v[64:67], v[32:35], v[96:111]
    s_add_u32 m0, s48, 33792
    s_nop 0
    buffer_load_dwordx4 v3, s[32:35], s53 offen lds
    s_waitcnt lgkmcnt(5)
    v_mfma_f32_32x32x16_bf16 v[80:95], v[52:55], v[36:39], v[80:95]
    ds_read_b128 v[44:47], v17 offset:0
    ds_read_b64_tr_b16 v[60:61], v22 offset:12288
    ds_read_b64_tr_b16 v[62:63], v22 offset:13312
    ds_read_b64_tr_b16 v[76:77], v23 offset:12288
    ds_read_b64_tr_b16 v[78:79], v23 offset:13312
    v_mfma_f32_32x32x16_bf16 v[96:111], v[68:71], v[36:39], v[96:111]
    s_add_u32 s52, s59, 6
    s_and_b32 s52, s52, 7
    s_mul_i32 s53, s52, 176128
    s_add_u32 m0, s49, 32768
    s_nop 0
    buffer_load_dwordx4 v4, s[36:39], s53 offen lds
    s_waitcnt lgkmcnt(5)
    v_mfma_f32_32x32x16_bf16 v[80:95], v[56:59], v[40:43], v[80:95]
    v_mfma_f32_32x32x16_bf16 v[96:111], v[72:75], v[40:43], v[96:111]
    s_add_u32 m0, s49, 33792
    s_nop 0
    buffer_load_dwordx4 v5, s[36:39], s53 offen lds
    s_waitcnt lgkmcnt(0)
    s_waitcnt vmcnt(4)
    s_barrier
    v_mfma_f32_32x32x16_bf16 v[80:95], v[60:63], v[44:47], v[80:95]
    ds_read_b128 v[32:35], v6 offset:0
    ds_read_b64_tr_b16 v[48:49], v18 offset:0
    ds_read_b64_tr_b16 v[50:51], v18 offset:1024
    ds_read_b64_tr_b16 v[64:65], v19 offset:0
    ds_read_b64_tr_b16 v[66:67], v19 offset:1024
    v_mfma_f32_32x32x16_bf16 v[96:111], v[76:79], v[44:47], v[96:111]
    ds_read_b128 v[36:39], v7 offset:0
    ds_read_b64_tr_b16 v[52:53], v18 offset:4096
    ds_read_b64_tr_b16 v[54:55], v18 offset:5120
    ds_read_b64_tr_b16 v[68:69], v19 offset:4096
    ds_read_b64_tr_b16 v[70:71], v19 offset:5120
    s_add_u32 s52, s59, 7
    s_and_b32 s52, s52, 7
    s_lshl_b32 s53, s52, 7
    s_add_u32 m0, s48, 65536
    s_nop 0
    buffer_load_dwordx4 v2, s[32:35], s53 offen lds
    s_waitcnt lgkmcnt(5)
    v_mfma_f32_32x32x16_bf16 v[80:95], v[48:51], v[32:35], v[80:95]
    ds_read_b128 v[40:43], v8 offset:0
    ds_read_b64_tr_b16 v[56:57], v18 offset:8192
    ds_read_b64_tr_b16 v[58:59], v18 offset:9216
    ds_read_b64_tr_b16 v[72:73], v19 offset:8192
    ds_read_b64_tr_b16 v[74:75], v19 offset:9216
    v_mfma_f32_32x32x16_bf16 v[96:111], v[64:67], v[32:35], v[96:111]
    s_add_u32 m0, s48, 66560
    s_nop 0
    buffer_load_dwordx4 v3, s[32:35], s53 offen lds
    s_waitcnt lgkmcnt(5)
    v_mfma_f32_32x32x16_bf16 v[80:95], v[52:55], v[36:39], v[80:95]
    ds_read_b128 v[44:47], v9 offset:0
    ds_read_b64_tr_b16 v[60:61], v18 offset:12288
    ds_read_b64_tr_b16 v[62:63], v18 offset:13312
    ds_read_b64_tr_b16 v[76:77], v19 offset:12288
    ds_read_b64_tr_b16 v[78:79], v19 offset:13312
    v_mfma_f32_32x32x16_bf16 v[96:111], v[68:71], v[36:39], v[96:111]
    s_add_u32 s52, s59, 7
    s_and_b32 s52, s52, 7
    s_mul_i32 s53, s52, 176128
    s_add_u32 m0, s49, 65536
    s_nop 0
    buffer_load_dwordx4 v4, s[36:39], s53 offen lds
    s_waitcnt lgkmcnt(5)
    v_mfma_f32_32x32x16_bf16 v[80:95], v[56:59], v[40:43], v[80:95]
    v_mfma_f32_32x32x16_bf16 v[96:111], v[72:75], v[40:43], v[96:111]
    s_add_u32 m0, s49, 66560
    s_nop 0
    buffer_load_dwordx4 v5, s[36:39], s53 offen lds
    s_waitcnt lgkmcnt(0)
    s_waitcnt vmcnt(4)
    s_barrier
    v_mfma_f32_32x32x16_bf16 v[80:95], v[60:63], v[44:47], v[80:95]
    ds_read_b128 v[32:35], v6 offset:32768
    ds_read_b64_tr_b16 v[48:49], v18 offset:32768
    ds_read_b64_tr_b16 v[50:51], v18 offset:33792
    ds_read_b64_tr_b16 v[64:65], v19 offset:32768
    ds_read_b64_tr_b16 v[66:67], v19 offset:33792
    v_mfma_f32_32x32x16_bf16 v[96:111], v[76:79], v[44:47], v[96:111]
    ds_read_b128 v[36:39], v7 offset:32768
    ds_read_b64_tr_b16 v[52:53], v18 offset:36864
    ds_read_b64_tr_b16 v[54:55], v18 offset:37888
    ds_read_b64_tr_b16 v[68:69], v19 offset:36864
    ds_read_b64_tr_b16 v[70:71], v19 offset:37888
    s_add_u32 m0, s68, 98304
    s_add_u32 s67, s66, 196608
    buffer_load_dwordx4 v240, s[40:43], s67 offen lds
    s_waitcnt lgkmcnt(5)
    v_mfma_f32_32x32x16_bf16 v[80:95], v[48:51], v[32:35], v[80:95]
    ds_read_b128 v[40:43], v8 offset:32768
    ds_read_b64_tr_b16 v[56:57], v18 offset:40960
    ds_read_b64_tr_b16 v[58:59], v18 offset:41984
    ds_read_b64_tr_b16 v[72:73], v19 offset:40960
    ds_read_b64_tr_b16 v[74:75], v19 offset:41984
    v_mfma_f32_32x32x16_bf16 v[96:111], v[64:67], v[32:35], v[96:111]
    s_add_u32 m0, s68, 99328
    s_add_u32 s67, s66, 204800
    buffer_load_dwordx4 v240, s[40:43], s67 offen lds
    s_waitcnt lgkmcnt(5)
    v_mfma_f32_32x32x16_bf16 v[80:95], v[52:55], v[36:39], v[80:95]
    ds_read_b128 v[44:47], v9 offset:32768
    ds_read_b64_tr_b16 v[60:61], v18 offset:45056
    ds_read_b64_tr_b16 v[62:63], v18 offset:46080
    ds_read_b64_tr_b16 v[76:77], v19 offset:45056
    ds_read_b64_tr_b16 v[78:79], v19 offset:46080
    v_mfma_f32_32x32x16_bf16 v[96:111], v[68:71], v[36:39], v[96:111]
    s_add_u32 m0, s68, 114688
    s_add_u32 s67, s66, 229376
    buffer_load_dwordx4 v240, s[40:43], s67 offen lds
    s_waitcnt lgkmcnt(5)
    v_mfma_f32_32x32x16_bf16 v[80:95], v[56:59], v[40:43], v[80:95]
    v_mfma_f32_32x32x16_bf16 v[96:111], v[72:75], v[40:43], v[96:111]
    s_add_u32 m0, s68, 115712
    s_add_u32 s67, s66, 237568
    buffer_load_dwordx4 v240, s[40:43], s67 offen lds
    s_waitcnt lgkmcnt(0)
    s_waitcnt vmcnt(4)
    s_barrier
    v_mfma_f32_32x32x16_bf16 v[80:95], v[60:63], v[44:47], v[80:95]
    ds_read_b128 v[32:35], v10 offset:0
    ds_read_b64_tr_b16 v[48:49], v20 offset:0
    ds_read_b64_tr_b16 v[50:51], v20 offset:1024
    ds_read_b64_tr_b16 v[64:65], v21 offset:0
    ds_read_b64_tr_b16 v[66:67], v21 offset:1024
    v_mfma_f32_32x32x16_bf16 v[96:111], v[76:79], v[44:47], v[96:111]
    ds_read_b128 v[36:39], v11 offset:0
    ds_read_b64_tr_b16 v[52:53], v20 offset:4096
    ds_read_b64_tr_b16 v[54:55], v20 offset:5120
    ds_read_b64_tr_b16 v[68:69], v21 offset:4096
    ds_read_b64_tr_b16 v[70:71], v21 offset:5120
    s_waitcnt lgkmcnt(5)
    v_mfma_f32_32x32x16_bf16 v[80:95], v[48:51], v[32:35], v[80:95]
    ds_read_b128 v[40:43], v12 offset:0
    ds_read_b64_tr_b16 v[56:57], v20 offset:8192
    ds_read_b64_tr_b16 v[58:59], v20 offset:9216
    ds_read_b64_tr_b16 v[72:73], v21 offset:8192
    ds_read_b64_tr_b16 v[74:75], v21 offset:9216
    v_mfma_f32_32x32x16_bf16 v[96:111], v[64:67], v[32:35], v[96:111]
    s_waitcnt lgkmcnt(5)
    v_mfma_f32_32x32x16_bf16 v[80:95], v[52:55], v[36:39], v[80:95]
    ds_read_b128 v[44:47], v13 offset:0
    ds_read_b64_tr_b16 v[60:61], v20 offset:12288
    ds_read_b64_tr_b16 v[62:63], v20 offset:13312
    ds_read_b64_tr_b16 v[76:77], v21 offset:12288
    ds_read_b64_tr_b16 v[78:79], v21 offset:13312
    v_mfma_f32_32x32x16_bf16 v[96:111], v[68:71], v[36:39], v[96:111]
    s_waitcnt lgkmcnt(5)
    v_mfma_f32_32x32x16_bf16 v[80:95], v[56:59], v[40:43], v[80:95]
    v_mfma_f32_32x32x16_bf16 v[96:111], v[72:75], v[40:43], v[96:111]
    s_waitcnt lgkmcnt(0)
    v_mfma_f32_32x32x16_bf16 v[80:95], v[60:63], v[44:47], v[80:95]
    v_mfma_f32_32x32x16_bf16 v[96:111], v[76:79], v[44:47], v[96:111]
    s_cmp_lg_u32 s3, 0
    s_cbranch_scc1 w0skip_2
    v_mov_b32 v248, 0
    buffer_load_dwordx2 v[250:251], v248, s[96:99], 0 offen
w0skip_2:
    s_mov_b32 s60, 0xc0135761
    s_mov_b32 s62, 0xbdd2d3e8
    s_mov_b32 s63, s62
    v_mov_b32 v30, s60
    v_mov_b32 v31, s60
    s_mul_i32 s57, s70, 352256
    s_mul_i32 s58, s56, 88064
    s_add_u32 s57, s57, s58
    s_lshl_b32 s55, s71, 2
    s_lshl_b32 s58, s54, 1
    s_add_u32 s55, s55, s58
    s_lshl_b32 s58, s55, 11
    s_add_u32 s57, s57, s58
    v_lshlrev_b32 v24, 4, v0
    s_cmp_ge_u32 s55, 43
    s_cbranch_scc1 g1skip_3
    v_pk_mul_f32 v[128:129], v[80:81], v[80:81]
    v_pk_mul_f32 v[130:131], v[82:83], v[82:83]
    v_pk_mul_f32 v[132:133], v[84:85], v[84:85]
    v_pk_mul_f32 v[134:135], v[86:87], v[86:87]
    v_pk_fma_f32 v[128:129], v[128:129], s[62:63], v[30:31]
    v_pk_fma_f32 v[130:131], v[130:131], s[62:63], v[30:31]
    v_pk_fma_f32 v[132:133], v[132:133], s[62:63], v[30:31]
    v_pk_fma_f32 v[134:135], v[134:135], s[62:63], v[30:31]
    v_pk_mul_f32 v[128:129], v[128:129], v[80:81]
    v_pk_mul_f32 v[130:131], v[130:131], v[82:83]
    v_pk_mul_f32 v[132:133], v[132:133], v[84:85]
    v_pk_mul_f32 v[134:135], v[134:135], v[86:87]
    v_exp_f32 v128, v128
    v_exp_f32 v129, v129
    v_exp_f32 v130, v130
    v_exp_f32 v131, v131
    v_exp_f32 v132, v132
    v_exp_f32 v133, v133
    v_exp_f32 v134, v134
    v_exp_f32 v135, v135
    v_pk_add_f32 v[128:129], v[128:129], 1.0 op_sel_hi:[1,0]
    v_pk_add_f32 v[130:131], v[130:131], 1.0 op_sel_hi:[1,0]
    v_pk_add_f32 v[132:133], v[132:133], 1.0 op_sel_hi:[1,0]
    v_pk_add_f32 v[134:135], v[134:135], 1.0 op_sel_hi:[1,0]
    v_rcp_f32 v128, v128
    v_rcp_f32 v129, v129
    v_rcp_f32 v130, v130
    v_rcp_f32 v131, v131
    v_rcp_f32 v132, v132
    v_rcp_f32 v133, v133
    v_rcp_f32 v134, v134
    v_rcp_f32 v135, v135
    v_pk_mul_f32 v[128:129], v[128:129], v[80:81]
    v_pk_mul_f32 v[130:131], v[130:131], v[82:83]
    v_pk_mul_f32 v[132:133], v[132:133], v[84:85]
    v_pk_mul_f32 v[134:135], v[134:135], v[86:87]
    v_cvt_pk_bf16_f32 v192, v128, v129
    v_cvt_pk_bf16_f32 v193, v130, v131
    v_cvt_pk_bf16_f32 v194, v132, v133
    v_cvt_pk_bf16_f32 v195, v134, v135
    buffer_store_dwordx4 v[192:195], v24, s[28:31], s57 offen offset:0 sc1
    v_pk_mul_f32 v[144:145], v[88:89], v[88:89]
    v_pk_mul_f32 v[146:147], v[90:91], v[90:91]
    v_pk_mul_f32 v[148:149], v[92:93], v[92:93]
    v_pk_mul_f32 v[150:151], v[94:95], v[94:95]
    v_pk_fma_f32 v[144:145], v[144:145], s[62:63], v[30:31]
    v_pk_fma_f32 v[146:147], v[146:147], s[62:63], v[30:31]
    v_pk_fma_f32 v[148:149], v[148:149], s[62:63], v[30:31]
    v_pk_fma_f32 v[150:151], v[150:151], s[62:63], v[30:31]
    v_pk_mul_f32 v[144:145], v[144:145], v[88:89]
    v_pk_mul_f32 v[146:147], v[146:147], v[90:91]
    v_pk_mul_f32 v[148:149], v[148:149], v[92:93]
    v_pk_mul_f32 v[150:151], v[150:151], v[94:95]
    v_exp_f32 v144, v144
    v_exp_f32 v145, v145
    v_exp_f32 v146, v146
    v_exp_f32 v147, v147
    v_exp_f32 v148, v148
    v_exp_f32 v149, v149
    v_exp_f32 v150, v150
    v_exp_f32 v151, v151
    v_pk_add_f32 v[144:145], v[144:145], 1.0 op_sel_hi:[1,0]
    v_pk_add_f32 v[146:147], v[146:147], 1.0 op_sel_hi:[1,0]
    v_pk_add_f32 v[148:149], v[148:149], 1.0 op_sel_hi:[1,0]
    v_pk_add_f32 v[150:151], v[150:151], 1.0 op_sel_hi:[1,0]
    v_rcp_f32 v144, v144
    v_rcp_f32 v145, v145
    v_rcp_f32 v146, v146
    v_rcp_f32 v147, v147
    v_rcp_f32 v148, v148
    v_rcp_f32 v149, v149
    v_rcp_f32 v150, v150
    v_rcp_f32 v151, v151
    v_pk_mul_f32 v[144:145], v[144:145], v[88:89]
    v_pk_mul_f32 v[146:147], v[146:147], v[90:91]
    v_pk_mul_f32 v[148:149], v[148:149], v[92:93]
    v_pk_mul_f32 v[150:151], v[150:151], v[94:95]
    v_cvt_pk_bf16_f32 v196, v144, v145
    v_cvt_pk_bf16_f32 v197, v146, v147
    v_cvt_pk_bf16_f32 v198, v148, v149
    v_cvt_pk_bf16_f32 v199, v150, v151
    buffer_store_dwordx4 v[196:199], v24, s[28:31], s57 offen offset:1024 sc1
g1skip_3:
    s_cmp_ge_u32 s55, 42
    s_cbranch_scc1 g1skip_4
    v_pk_mul_f32 v[160:161], v[96:97], v[96:97]
    v_pk_mul_f32 v[162:163], v[98:99], v[98:99]
    v_pk_mul_f32 v[164:165], v[100:101], v[100:101]
    v_pk_mul_f32 v[166:167], v[102:103], v[102:103]
    v_pk_fma_f32 v[160:161], v[160:161], s[62:63], v[30:31]
    v_pk_fma_f32 v[162:163], v[162:163], s[62:63], v[30:31]
    v_pk_fma_f32 v[164:165], v[164:165], s[62:63], v[30:31]
    v_pk_fma_f32 v[166:167], v[166:167], s[62:63], v[30:31]
    v_pk_mul_f32 v[160:161], v[160:161], v[96:97]
    v_pk_mul_f32 v[162:163], v[162:163], v[98:99]
    v_pk_mul_f32 v[164:165], v[164:165], v[100:101]
    v_pk_mul_f32 v[166:167], v[166:167], v[102:103]
    v_exp_f32 v160, v160
    v_exp_f32 v161, v161
    v_exp_f32 v162, v162
    v_exp_f32 v163, v163
    v_exp_f32 v164, v164
    v_exp_f32 v165, v165
    v_exp_f32 v166, v166
    v_exp_f32 v167, v167
    v_pk_add_f32 v[160:161], v[160:161], 1.0 op_sel_hi:[1,0]
    v_pk_add_f32 v[162:163], v[162:163], 1.0 op_sel_hi:[1,0]
    v_pk_add_f32 v[164:165], v[164:165], 1.0 op_sel_hi:[1,0]
    v_pk_add_f32 v[166:167], v[166:167], 1.0 op_sel_hi:[1,0]
    v_rcp_f32 v160, v160
    v_rcp_f32 v161, v161
    v_rcp_f32 v162, v162
    v_rcp_f32 v163, v163
    v_rcp_f32 v164, v164
    v_rcp_f32 v165, v165
    v_rcp_f32 v166, v166
    v_rcp_f32 v167, v167
    v_pk_mul_f32 v[160:161], v[160:161], v[96:97]
    v_pk_mul_f32 v[162:163], v[162:163], v[98:99]
    v_pk_mul_f32 v[164:165], v[164:165], v[100:101]
    v_pk_mul_f32 v[166:167], v[166:167], v[102:103]
    v_cvt_pk_bf16_f32 v200, v160, v161
    v_cvt_pk_bf16_f32 v201, v162, v163
    v_cvt_pk_bf16_f32 v202, v164, v165
    v_cvt_pk_bf16_f32 v203, v166, v167
    buffer_store_dwordx4 v[200:203], v24, s[28:31], s57 offen offset:2048 sc1
    v_pk_mul_f32 v[176:177], v[104:105], v[104:105]
    v_pk_mul_f32 v[178:179], v[106:107], v[106:107]
    v_pk_mul_f32 v[180:181], v[108:109], v[108:109]
    v_pk_mul_f32 v[182:183], v[110:111], v[110:111]
    v_pk_fma_f32 v[176:177], v[176:177], s[62:63], v[30:31]
    v_pk_fma_f32 v[178:179], v[178:179], s[62:63], v[30:31]
    v_pk_fma_f32 v[180:181], v[180:181], s[62:63], v[30:31]
    v_pk_fma_f32 v[182:183], v[182:183], s[62:63], v[30:31]
    v_pk_mul_f32 v[176:177], v[176:177], v[104:105]
    v_pk_mul_f32 v[178:179], v[178:179], v[106:107]
    v_pk_mul_f32 v[180:181], v[180:181], v[108:109]
    v_pk_mul_f32 v[182:183], v[182:183], v[110:111]
    v_exp_f32 v176, v176
    v_exp_f32 v177, v177
    v_exp_f32 v178, v178
    v_exp_f32 v179, v179
    v_exp_f32 v180, v180
    v_exp_f32 v181, v181
    v_exp_f32 v182, v182
    v_exp_f32 v183, v183
    v_pk_add_f32 v[176:177], v[176:177], 1.0 op_sel_hi:[1,0]
    v_pk_add_f32 v[178:179], v[178:179], 1.0 op_sel_hi:[1,0]
    v_pk_add_f32 v[180:181], v[180:181], 1.0 op_sel_hi:[1,0]
    v_pk_add_f32 v[182:183], v[182:183], 1.0 op_sel_hi:[1,0]
    v_rcp_f32 v176, v176
    v_rcp_f32 v177, v177
    v_rcp_f32 v178, v178
    v_rcp_f32 v179, v179
    v_rcp_f32 v180, v180
    v_rcp_f32 v181, v181
    v_rcp_f32 v182, v182
    v_rcp_f32 v183, v183
    v_pk_mul_f32 v[176:177], v[176:177], v[104:105]
    v_pk_mul_f32 v[178:179], v[178:179], v[106:107]
    v_pk_mul_f32 v[180:181], v[180:181], v[108:109]
    v_pk_mul_f32 v[182:183], v[182:183], v[110:111]
    v_cvt_pk_bf16_f32 v204, v176, v177
    v_cvt_pk_bf16_f32 v205, v178, v179
    v_cvt_pk_bf16_f32 v206, v180, v181
    v_cvt_pk_bf16_f32 v207, v182, v183
    buffer_store_dwordx4 v[204:207], v24, s[28:31], s57 offen offset:3072 sc1
g1skip_4:
    v_bfe_u32 v2, v0, 2, 2
    v_lshrrev_b32 v3, 5, v0
    v_lshl_add_u32 v3, v3, 2, v2
    v_lshlrev_b32 v3, 7, v3
    v_bfe_u32 v4, v0, 4, 1
    v_and_b32 v5, 1, v0
    v_lshl_add_u32 v4, v4, 1, v5
    v_bfe_u32 v5, v0, 3, 1
    v_lshl_add_u32 v4, v5, 2, v4
    v_lshl_add_u32 v3, v4, 4, v3
    v_bfe_u32 v5, v0, 1, 1
    v_lshl_add_u32 v3, v5, 3, v3
    s_lshl_b32 s67, s65, 12
    v_add_u32 v20, s67, v3
    v_xor_b32 v21, 64, v20
    v_add_u32 v22, 65536, v20
    v_add_u32 v23, 65536, v21
    v_add_u32 v24, 131072, v20
    v_add_u32 v25, 131072, v21
    v_lshlrev_b32 v19, 4, v0
    s_mul_i32 s67, s64, 24576
    s_add_u32 s67, s67, 32768
    v_add_u32 v26, s67, v19
    s_mul_i32 s69, s65, 6144
    v_add_u32 v27, s69, v26
    s_lshl_b32 s69, s75, 6
    s_lshl_b32 s67, s64, 5
    s_add_u32 s69, s69, s67
    v_and_b32 v2, 31, v0
    v_add_u32 v2, s69, v2
    v_lshlrev_b32 v34, 2, v2
    v_lshlrev_b32 v3, 4, v2
    v_add_u32 v3, s74, v3
    v_cvt_f32_u32 v29, v3
    v_lshlrev_b32 v3, 10, v3
    v_lshrrev_b32 v4, 5, v0
    v_lshlrev_b32 v4, 4, v4
    s_lshl_b32 s67, s76, 7
    s_lshl_b32 s69, s65, 5
    s_add_u32 s67, s67, s69
    v_add_u32 v4, s67, v4
    v_add_u32 v28, v3, v4
    v_mov_b32 v30, v4
    s_mov_b32 s36, s18
    s_and_b32 s37, s19, 0xffff
    s_mov_b32 s38, 0x400
    s_mov_b32 s39, 0x20000
    buffer_load_dwordx4 v[30:33], v30, s[36:39], 0 offen
    s_waitcnt vmcnt(1)
    s_barrier
    s_cmp_lg_u32 s3, 0
    s_cbranch_scc1 w0skip_5
    s_mov_b32 s49, 65536
    v_mov_b32 v248, 0
nretry_6:
    v_readfirstlane_b32 s78, v250
    v_readfirstlane_b32 s79, v251
    s_cmp_lg_u32 s78, 0
    s_cbranch_scc1 nok_7
    s_sub_u32 s49, s49, 1
    s_cmp_eq_u32 s49, 0
    s_cbranch_scc1 nok_7
nld_8:
    buffer_load_dwordx2 v[250:251], v248, s[96:99], 0 offen sc1
    s_waitcnt vmcnt(0)
    s_branch nretry_6
nok_7:
    s_lshl_b32 s48, s70, 9
    s_lshl_b32 s49, s71, 3
    s_add_u32 s48, s48, s49
    s_add_u32 s48, s48, 12648448
    v_lshl_add_u32 v248, v0, 8, s48
    v_mov_b32 v250, s78
    v_mov_b32 v251, s79
    s_mov_b64 exec, 0x3
    buffer_store_dwordx2 v[250:251], v248, s[28:31], 0 offen sc1
    s_mov_b64 exec, -1
w0skip_5:
    s_add_u32 m0, s68, 131072
    s_add_u32 s67, s66, 262144
    buffer_load_dwordx4 v240, s[40:43], s67 offen lds
    s_add_u32 m0, s68, 132096
    s_add_u32 s67, s66, 270336
    buffer_load_dwordx4 v240, s[40:43], s67 offen lds
    s_add_u32 m0, s68, 147456
    s_add_u32 s67, s66, 294912
    buffer_load_dwordx4 v240, s[40:43], s67 offen lds
    s_add_u32 m0, s68, 148480
    s_add_u32 s67, s66, 303104
    buffer_load_dwordx4 v240, s[40:43], s67 offen lds
    s_add_u32 m0, s68, 0
    s_add_u32 s67, s66, 0
    buffer_load_dwordx4 v240, s[40:43], s67 offen lds
    s_add_u32 m0, s68, 1024
    s_add_u32 s67, s66, 8192
    buffer_load_dwordx4 v240, s[40:43], s67 offen lds
    s_add_u32 m0, s68, 16384
    s_add_u32 s67, s66, 32768
    buffer_load_dwordx4 v240, s[40:43], s67 offen lds
    s_add_u32 m0, s68, 17408
    s_add_u32 s67, s66, 40960
    buffer_load_dwordx4 v240, s[40:43], s67 offen lds
    s_add_u32 m0, s68, 32768
    s_add_u32 s67, s66, 65536
    buffer_load_dwordx4 v240, s[40:43], s67 offen lds
    s_add_u32 m0, s68, 33792
    s_add_u32 s67, s66, 73728
    buffer_load_dwordx4 v240, s[40:43], s67 offen lds
    s_add_u32 m0, s68, 49152
    s_add_u32 s67, s66, 98304
    buffer_load_dwordx4 v240, s[40:43], s67 offen lds
    s_add_u32 m0, s68, 50176
    s_add_u32 s67, s66, 106496
    buffer_load_dwordx4 v240, s[40:43], s67 offen lds
    s_add_u32 m0, s68, 65536
    s_add_u32 s67, s66, 131072
    buffer_load_dwordx4 v240, s[40:43], s67 offen lds
    s_add_u32 m0, s68, 66560
    s_add_u32 s67, s66, 139264
    buffer_load_dwordx4 v240, s[40:43], s67 offen lds
    s_add_u32 m0, s68, 81920
    s_add_u32 s67, s66, 163840
    buffer_load_dwordx4 v240, s[40:43], s67 offen lds
    s_add_u32 m0, s68, 82944
    s_add_u32 s67, s66, 172032
    buffer_load_dwordx4 v240, s[40:43], s67 offen lds
    s_branch L_final
L_notg1:
    s_cmp_ge_u32 s73, 30
    s_cbranch_scc1 L_nop1
    s_sub_u32 s77, s73, 22
    s_and_b32 s70, s77, 1
    s_lshl_b32 s71, s72, 1
    s_add_u32 s70, s70, s71
    s_lshr_b32 s71, s77, 1
    s_lshl_b32 s77, s77, 3
    s_add_u32 s77, s77, s72
    v_and_b32 v16, 15, v0
    v_lshrrev_b32 v17, 4, v0
    v_lshrrev_b32 v2, 4, v0
    v_lshlrev_b32 v3, 2, v2
    v_and_b32 v4, 15, v0
    v_xor_b32 v3, v3, v4
    v_lshlrev_b32 v3, 4, v3
    v_lshl_add_u32 v86, v2, 14, v3
    s_lshl_b32 s50, s70, 10
    s_lshl_b32 s51, s71, 8
    s_add_u32 s50, s50, s51
    s_lshl_b32 s51, s3, 18
    s_add_u32 s50, s50, s51
    s_lshl_b32 s52, s3, 12
    s_add_u32 s52, s52, 81920
    s_and_b32 s54, s3, 3
    s_lshr_b32 s55, s3, 2
    v_bfe_u32 v2, v0, 1, 4
    s_lshl_b32 s56, s54, 4
    v_add_u32 v2, s56, v2
    v_cvt_f32_u32 v3, v2
    v_mul_f32 v4, 0x3c000000, v3
    v_cvt_f32_u32 v5, s70
    v_mul_f32 v5, 0x3a000000, v5
    v_mul_f32 v5, v5, v3
    v_and_b32 v6, 1, v0
    v_cvt_f32_u32 v7, v6
    v_fmac_f32 v5, 0.25, v7
    v_lshl_or_b32 v8, v2, 1, v6
    v_cmp_eq_u32 vcc, 1, v8
    v_mov_b32 v9, 0.5
    s_nop 0
    v_cndmask_b32 v4, v4, v9, vcc
    v_mov_b32 v9, 0
    v_cndmask_b32 v5, v5, v9, vcc
    v_lshrrev_b32 v6, 5, v0
    v_lshlrev_b32 v6, 3, v6
    v_cvt_f32_u32 v6, v6
    v_fmac_f32 v5, v6, v4
    v_mov_b32 v144, v5
    v_fmamk_f32 v145, v4, 0x3f800000, v5
    v_fmamk_f32 v146, v4, 0x40000000, v5
    v_fmamk_f32 v147, v4, 0x40400000, v5
    v_fmamk_f32 v148, v4, 0x40800000, v5
    v_fmamk_f32 v149, v4, 0x40a00000, v5
    v_fmamk_f32 v150, v4, 0x40c00000, v5
    v_fmamk_f32 v151, v4, 0x40e00000, v5
    v_cos_f32 v144, v144
    v_cos_f32 v145, v145
    v_cos_f32 v146, v146
    v_cos_f32 v147, v147
    v_cos_f32 v148, v148
    v_cos_f32 v149, v149
    v_cos_f32 v150, v150
    v_cos_f32 v151, v151
    v_fmamk_f32 v152, v4, 0x41800000, v5
    v_fmamk_f32 v153, v4, 0x41880000, v5
    v_fmamk_f32 v154, v4, 0x41900000, v5
    v_fmamk_f32 v155, v4, 0x41980000, v5
    v_fmamk_f32 v156, v4, 0x41a00000, v5
    v_fmamk_f32 v157, v4, 0x41a80000, v5
    v_fmamk_f32 v158, v4, 0x41b00000, v5
    v_fmamk_f32 v159, v4, 0x41b80000, v5
    v_cos_f32 v152, v152
    v_cos_f32 v153, v153
    v_cos_f32 v154, v154
    v_cos_f32 v155, v155
    v_cos_f32 v156, v156
    v_cos_f32 v157, v157
    v_cos_f32 v158, v158
    v_cos_f32 v159, v159
    v_mul_f32 v10, 0x41800000, v4
    v_cos_f32 v10, v10
    s_nop 0
    v_add_f32 v10, v10, v10
    s_waitcnt lgkmcnt(0)
    s_mov_b32 s28, s26
    s_and_b32 s29, s27, 0xffff
    s_mov_b32 s30, 0x1000000
    s_mov_b32 s31, 0x20000
    s_mov_b32 s32, s4
    s_and_b32 s33, s5, 0xffff
    s_mov_b32 s34, 0x200000
    s_mov_b32 s35, 0x20000
    s_add_u32 m0, s52, 0
    s_add_u32 s53, s50, 0
    s_mov_b32 s36, s20
    s_and_b32 s37, s21, 0xffff
    s_mov_b32 s38, 0x400
    s_mov_b32 s39, 0x20000
    s_lshl_b32 s51, s71, 8
    v_lshlrev_b32 v11, 4, v0
    s_mov_b64 exec, 0xffff
    s_mov_b32 m0, 158720
    s_nop 0
    buffer_load_dwordx4 v11, s[36:39], s51 offen lds
    s_mov_b64 exec, -1
    s_add_u32 m0, s52, 0
    s_nop 0
    buffer_load_dwordx4 v86, s[32:35], s53 offen lds
    s_add_u32 m0, s52, 1024
    s_add_u32 s53, s50, 65536
    buffer_load_dwordx4 v86, s[32:35], s53 offen lds
    s_add_u32 m0, s52, 2048
    s_add_u32 s53, s50, 131072
    buffer_load_dwordx4 v86, s[32:35], s53 offen lds
    s_add_u32 m0, s52, 3072
    s_add_u32 s53, s50, 196608
    buffer_load_dwordx4 v86, s[32:35], s53 offen lds
    v_cvt_pk_bf16_f32 v36, v144, v145
    v_cvt_pk_bf16_f32 v37, v146, v147
    v_cvt_pk_bf16_f32 v38, v148, v149
    v_cvt_pk_bf16_f32 v39, v150, v151
    v_cvt_pk_bf16_f32 v40, v152, v153
    v_cvt_pk_bf16_f32 v41, v154, v155
    v_cvt_pk_bf16_f32 v42, v156, v157
    v_cvt_pk_bf16_f32 v43, v158, v159
    v_fma_f32 v144, v10, v152, -v144
    v_fma_f32 v145, v10, v153, -v145
    v_fma_f32 v146, v10, v154, -v146
    v_fma_f32 v147, v10, v155, -v147
    v_fma_f32 v148, v10, v156, -v148
    v_fma_f32 v149, v10, v157, -v149
    v_fma_f32 v150, v10, v158, -v150
    v_fma_f32 v151, v10, v159, -v151
    v_cvt_pk_bf16_f32 v44, v144, v145
    v_cvt_pk_bf16_f32 v45, v146, v147
    v_cvt_pk_bf16_f32 v46, v148, v149
    v_cvt_pk_bf16_f32 v47, v150, v151
    v_fma_f32 v152, v10, v144, -v152
    v_fma_f32 v153, v10, v145, -v153
    v_fma_f32 v154, v10, v146, -v154
    v_fma_f32 v155, v10, v147, -v155
    v_fma_f32 v156, v10, v148, -v156
    v_fma_f32 v157, v10, v149, -v157
    v_fma_f32 v158, v10, v150, -v158
    v_fma_f32 v159, v10, v151, -v159
    v_cvt_pk_bf16_f32 v48, v152, v153
    v_cvt_pk_bf16_f32 v49, v154, v155
    v_cvt_pk_bf16_f32 v50, v156, v157
    v_cvt_pk_bf16_f32 v51, v158, v159
    v_fma_f32 v144, v10, v152, -v144
    v_fma_f32 v145, v10, v153, -v145
    v_fma_f32 v146, v10, v154, -v146
    v_fma_f32 v147, v10, v155, -v147
    v_fma_f32 v148, v10, v156, -v148
    v_fma_f32 v149, v10, v157, -v149
    v_fma_f32 v150, v10, v158, -v150
    v_fma_f32 v151, v10, v159, -v151
    v_cvt_pk_bf16_f32 v52, v144, v145
    v_cvt_pk_bf16_f32 v53, v146, v147
    v_cvt_pk_bf16_f32 v54, v148, v149
    v_cvt_pk_bf16_f32 v55, v150, v151
    v_fma_f32 v152, v10, v144, -v152
    v_fma_f32 v153, v10, v145, -v153
    v_fma_f32 v154, v10, v146, -v154
    v_fma_f32 v155, v10, v147, -v155
    v_fma_f32 v156, v10, v148, -v156
    v_fma_f32 v157, v10, v149, -v157
    v_fma_f32 v158, v10, v150, -v158
    v_fma_f32 v159, v10, v151, -v159
    v_cvt_pk_bf16_f32 v56, v152, v153
    v_cvt_pk_bf16_f32 v57, v154, v155
    v_cvt_pk_bf16_f32 v58, v156, v157
    v_cvt_pk_bf16_f32 v59, v158, v159
    v_fma_f32 v144, v10, v152, -v144
    v_fma_f32 v145, v10, v153, -v145
    v_fma_f32 v146, v10, v154, -v146
    v_fma_f32 v147, v10, v155, -v147
    v_fma_f32 v148, v10, v156, -v148
    v_fma_f32 v149, v10, v157, -v149
    v_fma_f32 v150, v10, v158, -v150
    v_fma_f32 v151, v10, v159, -v151
    v_cvt_pk_bf16_f32 v60, v144, v145
    v_cvt_pk_bf16_f32 v61, v146, v147
    v_cvt_pk_bf16_f32 v62, v148, v149
    v_cvt_pk_bf16_f32 v63, v150, v151
    v_fma_f32 v152, v10, v144, -v152
    v_fma_f32 v153, v10, v145, -v153
    v_fma_f32 v154, v10, v146, -v154
    v_fma_f32 v155, v10, v147, -v155
    v_fma_f32 v156, v10, v148, -v156
    v_fma_f32 v157, v10, v149, -v157
    v_fma_f32 v158, v10, v150, -v158
    v_fma_f32 v159, v10, v151, -v159
    v_cvt_pk_bf16_f32 v64, v152, v153
    v_cvt_pk_bf16_f32 v65, v154, v155
    v_cvt_pk_bf16_f32 v66, v156, v157
    v_cvt_pk_bf16_f32 v67, v158, v159
    s_mov_b32 s40, s6
    s_and_b32 s41, s7, 0xffff
    s_mov_b32 s42, 0x101000
    s_mov_b32 s43, 0x20000
    s_mov_b32 s44, s8
    s_and_b32 s45, s9, 0xffff
    s_mov_b32 s46, 0x101000
    s_mov_b32 s47, 0x20000
    s_mov_b32 s96, s24
    s_and_b32 s97, s25, 0xffff
    s_mov_b32 s98, 0x100
    s_mov_b32 s99, 0x20000
    v_lshlrev_b32 v12, 4, v0
    v_cmp_gt_u32 vcc, 32, v0
    s_and_b32 s53, s77, 1
    s_lshl_b32 s53, s53, 1
    s_lshl_b32 s50, s3, 1
    s_add_u32 s50, s50, 0
    s_lshl_b32 s50, s50, 7
    s_add_u32 s50, s50, s77
    s_sub_u32 s51, 2048, s50
    s_and_b32 s51, s51, 2047
    s_mul_i32 s50, s50, 514
    s_mul_i32 s51, s51, 514
    s_sub_u32 s50, s50, s53
    s_add_u32 s51, s51, s53
    s_sub_u32 s52, s51, 512
    v_mov_b32 v142, s52
    v_mov_b32 v13, s50
    v_cndmask_b32 v142, v142, v13, vcc
    v_add_u32 v142, v142, v12
    s_add_u32 s50, s50, 512
    v_mov_b32 v141, s50
    s_add_u32 s52, s51, 512
    v_writelane_b32 v141, s52, 63
    s_sub_u32 s51, s51, s53
    s_sub_u32 s51, s51, s53
    v_writelane_b32 v141, s51, 0
    s_lshl_b32 s50, s3, 1
    s_add_u32 s50, s50, 1
    s_lshl_b32 s50, s50, 7
    s_add_u32 s50, s50, s77
    s_sub_u32 s51, 2048, s50
    s_and_b32 s51, s51, 2047
    s_mul_i32 s50, s50, 514
    s_mul_i32 s51, s51, 514
    s_sub_u32 s50, s50, s53
    s_add_u32 s51, s51, s53
    s_sub_u32 s52, s51, 512
    v_mov_b32 v143, s52
    v_mov_b32 v13, s50
    v_cndmask_b32 v143, v143, v13, vcc
    v_add_u32 v143, v143, v12
    s_add_u32 s50, s50, 512
    v_mov_b32 v15, s50
    s_add_u32 s52, s51, 512
    v_writelane_b32 v15, s52, 63
    s_sub_u32 s51, s51, s53
    s_sub_u32 s51, s51, s53
    v_writelane_b32 v15, s51, 0
    v_bfe_u32 v2, v0, 2, 2
    v_lshrrev_b32 v3, 5, v0
    v_lshl_add_u32 v3, v3, 3, v2
    v_lshlrev_b32 v3, 8, v3
    v_bfe_u32 v6, v0, 4, 1
    v_bfe_u32 v7, v0, 1, 1
    v_lshl_add_u32 v6, v6, 1, v7
    v_and_b32 v7, 1, v0
    v_lshl_add_u32 v3, v7, 3, v3
    v_add_u32 v3, 81920, v3
    s_lshl_b32 s58, s55, 1
    s_add_u32 s58, s58, 0
    v_xor_b32 v8, s58, v2
    v_lshl_add_u32 v8, v8, 2, v6
    v_lshl_add_u32 v84, v8, 4, v3
    s_lshl_b32 s58, s55, 1
    s_add_u32 s58, s58, 1
    v_xor_b32 v8, s58, v2
    v_lshl_add_u32 v8, v8, 2, v6
    v_lshl_add_u32 v85, v8, 4, v3
    v_and_b32 v2, 31, v0
    s_lshl_b32 s58, s54, 5
    v_add_u32 v2, s58, v2
    v_mul_u32_u24 v2, 272, v2
    v_lshrrev_b32 v3, 5, v0
    v_lshl_add_u32 v2, v3, 4, v2
    s_lshl_b32 s58, s55, 7
    s_add_u32 s58, s58, 114688
    v_add_u32 v136, s58, v2
    v_lshrrev_b32 v2, 4, v0
    s_lshl_b32 s58, s3, 4
    v_add_u32 v3, s58, v2
    v_mul_u32_u24 v3, 272, v3
    v_and_b32 v4, 15, v0
    v_lshl_add_u32 v3, v4, 4, v3
    v_add_u32 v137, 114688, v3
    v_lshrrev_b32 v5, 1, v2
    v_lshlrev_b32 v5, 15, v5
    v_and_b32 v6, 1, v2
    v_lshl_add_u32 v5, v6, 10, v5
    v_lshl_add_u32 v138, v4, 4, v5
    v_lshrrev_b32 v7, 2, v0
    s_lshl_b32 s59, s3, 4
    v_add_u32 v7, s59, v7
    v_and_b32 v8, 3, v0
    v_and_b32 v9, 3, v7
    v_xor_b32 v8, v8, v9
    v_lshlrev_b32 v8, 6, v8
    v_lshl_add_u32 v139, v7, 8, v8
    v_add_u32 v139, 81920, v139
    v_lshlrev_b32 v140, 2, v7
    s_lshl_b32 s58, s3, 18
    s_lshl_b32 s59, s70, 11
    s_add_u32 s58, s58, s59
    s_lshl_b32 s59, s71, 8
    s_add_u32 s58, s58, s59
    s_add_u32 s58, s58, 6291456
    s_lshl_b32 s57, s71, 4
    s_add_u32 s57, s57, s70
    s_lshl_b32 s57, s57, 9
    s_add_u32 s57, s57, 10485760
    v_and_b32 v2, 3, v0
    v_lshlrev_b32 v2, 6, v2
    v_add_u32 v2, 158720, v2
    s_waitcnt vmcnt(0)
    s_barrier
    ds_read_b64_tr_b16 v[176:177], v84 offset:0
    ds_read_b64_tr_b16 v[178:179], v84 offset:1024
    ds_read_b64_tr_b16 v[208:209], v85 offset:0
    ds_read_b64_tr_b16 v[210:211], v85 offset:1024
    ds_read_b64_tr_b16 v[180:181], v84 offset:4096
    ds_read_b64_tr_b16 v[182:183], v84 offset:5120
    ds_read_b64_tr_b16 v[212:213], v85 offset:4096
    ds_read_b64_tr_b16 v[214:215], v85 offset:5120
    ds_read_b64_tr_b16 v[184:185], v84 offset:8192
    ds_read_b64_tr_b16 v[186:187], v84 offset:9216
    ds_read_b64_tr_b16 v[216:217], v85 offset:8192
    ds_read_b64_tr_b16 v[218:219], v85 offset:9216
    s_waitcnt lgkmcnt(8)
    v_mfma_f32_32x32x16_bf16 v[144:159], v[176:179], v[36:39], 0
    v_mfma_f32_32x32x16_bf16 v[160:175], v[208:211], v[36:39], 0
    ds_read_b64_tr_b16 v[188:189], v84 offset:12288
    ds_read_b64_tr_b16 v[190:191], v84 offset:13312
    ds_read_b64_tr_b16 v[220:221], v85 offset:12288
    ds_read_b64_tr_b16 v[222:223], v85 offset:13312
    buffer_load_dwordx4 v[114:117], v142, s[40:43], 0 offen
    buffer_load_dwordx4 v[118:121], v142, s[44:47], 0 offen
    s_waitcnt lgkmcnt(8)
    v_mfma_f32_32x32x16_bf16 v[144:159], v[180:183], v[40:43], v[144:159]
    v_mfma_f32_32x32x16_bf16 v[160:175], v[212:215], v[40:43], v[160:175]
    ds_read_b64_tr_b16 v[192:193], v84 offset:16384
    ds_read_b64_tr_b16 v[194:195], v84 offset:17408
    ds_read_b64_tr_b16 v[224:225], v85 offset:16384
    ds_read_b64_tr_b16 v[226:227], v85 offset:17408
    s_waitcnt lgkmcnt(8)
    v_mfma_f32_32x32x16_bf16 v[144:159], v[184:187], v[44:47], v[144:159]
    v_mfma_f32_32x32x16_bf16 v[160:175], v[216:219], v[44:47], v[160:175]
    ds_read_b64_tr_b16 v[196:197], v84 offset:20480
    ds_read_b64_tr_b16 v[198:199], v84 offset:21504
    ds_read_b64_tr_b16 v[228:229], v85 offset:20480
    ds_read_b64_tr_b16 v[230:231], v85 offset:21504
    s_mov_b32 exec_lo, 0x80000001
    s_mov_b32 exec_hi, 0x80000001
    buffer_load_dword v130, v141, s[40:43], 0 offen
    buffer_load_dword v131, v141, s[44:47], 0 offen
    s_mov_b64 exec, -1
    s_waitcnt lgkmcnt(8)
    v_mfma_f32_32x32x16_bf16 v[144:159], v[188:191], v[48:51], v[144:159]
    v_mfma_f32_32x32x16_bf16 v[160:175], v[220:223], v[48:51], v[160:175]
    ds_read_b64_tr_b16 v[200:201], v84 offset:24576
    ds_read_b64_tr_b16 v[202:203], v84 offset:25600
    ds_read_b64_tr_b16 v[232:233], v85 offset:24576
    ds_read_b64_tr_b16 v[234:235], v85 offset:25600
    s_waitcnt lgkmcnt(8)
    v_mfma_f32_32x32x16_bf16 v[144:159], v[192:195], v[52:55], v[144:159]
    v_mfma_f32_32x32x16_bf16 v[160:175], v[224:227], v[52:55], v[160:175]
    ds_read_b64_tr_b16 v[204:205], v84 offset:28672
    ds_read_b64_tr_b16 v[206:207], v84 offset:29696
    ds_read_b64_tr_b16 v[236:237], v85 offset:28672
    ds_read_b64_tr_b16 v[238:239], v85 offset:29696
    buffer_load_dwordx4 v[122:125], v143, s[40:43], 0 offen
    buffer_load_dwordx4 v[126:129], v143, s[44:47], 0 offen
    s_waitcnt lgkmcnt(8)
    v_mfma_f32_32x32x16_bf16 v[144:159], v[196:199], v[56:59], v[144:159]
    v_mfma_f32_32x32x16_bf16 v[160:175], v[228:231], v[56:59], v[160:175]
    s_waitcnt lgkmcnt(4)
    v_mfma_f32_32x32x16_bf16 v[144:159], v[200:203], v[60:63], v[144:159]
    v_mfma_f32_32x32x16_bf16 v[160:175], v[232:235], v[60:63], v[160:175]
    s_mov_b32 exec_lo, 0x80000001
    s_mov_b32 exec_hi, 0x80000001
    buffer_load_dword v132, v15, s[40:43], 0 offen
    buffer_load_dword v133, v15, s[44:47], 0 offen
    s_mov_b64 exec, -1
    s_waitcnt lgkmcnt(0)
    v_mfma_f32_32x32x16_bf16 v[144:159], v[204:207], v[64:67], v[144:159]
    v_mfma_f32_32x32x16_bf16 v[160:175], v[236:239], v[64:67], v[160:175]
    ds_read_b128 v[176:179], v139 offset:0
    ds_read_b128 v[20:23], v2 offset:0
    ds_read_b128 v[180:183], v139 offset:16
    ds_read_b128 v[24:27], v2 offset:16
    ds_read_b128 v[184:187], v139 offset:32
    ds_read_b128 v[28:31], v2 offset:32
    ds_read_b128 v[188:191], v139 offset:48
    ds_read_b128 v[32:35], v2 offset:48
    v_mov_b32 v248, 0
    buffer_load_dwordx2 v[250:251], v248, s[96:99], 0 offen
    s_nop 0
    v_cvt_pk_bf16_f32 v36, v144, v145
    v_cvt_pk_bf16_f32 v37, v146, v147
    v_cvt_pk_bf16_f32 v38, v148, v149
    v_cvt_pk_bf16_f32 v39, v150, v151
    v_cvt_pk_bf16_f32 v40, v152, v153
    v_cvt_pk_bf16_f32 v41, v154, v155
    v_cvt_pk_bf16_f32 v42, v156, v157
    v_cvt_pk_bf16_f32 v43, v158, v159
    v_permlane32_swap_b32 v36, v38
    v_permlane32_swap_b32 v37, v39
    ds_write_b128 v136, v[36:39] offset:0
    v_permlane32_swap_b32 v40, v42
    v_permlane32_swap_b32 v41, v43
    ds_write_b128 v136, v[40:43] offset:32
    s_waitcnt lgkmcnt(2)
    v_mov_b32 v9, 0
    v_mov_b32 v8, 0
    v_cvt_pk_bf16_f32 v44, v160, v161
    v_dot2_f32_bf16 v8, v176, v20, v8
    v_cvt_pk_bf16_f32 v45, v162, v163
    v_dot2_f32_bf16 v9, v177, v21, v9
    v_cvt_pk_bf16_f32 v46, v164, v165
    v_dot2_f32_bf16 v8, v178, v22, v8
    v_dot2_f32_bf16 v9, v179, v23, v9
    v_cvt_pk_bf16_f32 v47, v166, v167
    v_dot2_f32_bf16 v8, v180, v24, v8
    v_cvt_pk_bf16_f32 v48, v168, v169
    v_dot2_f32_bf16 v9, v181, v25, v9
    v_cvt_pk_bf16_f32 v49, v170, v171
    v_dot2_f32_bf16 v8, v182, v26, v8
    v_cvt_pk_bf16_f32 v50, v172, v173
    v_dot2_f32_bf16 v9, v183, v27, v9
    v_dot2_f32_bf16 v8, v184, v28, v8
    v_cvt_pk_bf16_f32 v51, v174, v175
    v_dot2_f32_bf16 v9, v185, v29, v9
    v_permlane32_swap_b32 v44, v46
    v_dot2_f32_bf16 v8, v186, v30, v8
    v_permlane32_swap_b32 v45, v47
    v_dot2_f32_bf16 v9, v187, v31, v9
    v_dot2_f32_bf16 v8, v188, v32, v8
    ds_write_b128 v136, v[44:47] offset:64
    v_dot2_f32_bf16 v9, v189, v33, v9
    v_permlane32_swap_b32 v48, v50
    v_dot2_f32_bf16 v8, v190, v34, v8
    v_permlane32_swap_b32 v49, v51
    v_dot2_f32_bf16 v9, v191, v35, v9
    ds_write_b128 v136, v[48:51] offset:96
    s_nop 1
    v_add_f32 v9, v9, v8
    s_nop 1
    v_add_f32_dpp v9, v9, v9 quad_perm:[1,0,3,2] row_mask:0xf bank_mask:0xf
    s_nop 1
    v_add_f32_dpp v9, v9, v9 quad_perm:[2,3,0,1] row_mask:0xf bank_mask:0xf
    s_mov_b32 exec_lo, 0x11111111
    s_mov_b32 exec_hi, 0x11111111
    buffer_store_dword v9, v140, s[28:31], s57 offen sc1
    s_mov_b64 exec, -1
    s_waitcnt lgkmcnt(0)
    s_barrier
    ds_read_b128 v[68:71], v137 offset:0
    ds_read_b128 v[72:75], v137 offset:1088
    ds_read_b128 v[76:79], v137 offset:2176
    ds_read_b128 v[80:83], v137 offset:3264
    s_waitcnt lgkmcnt(3)
    s_add_u32 s59, s58, 0
    buffer_store_dwordx4 v[68:71], v138, s[28:31], s59 offen sc1
    s_waitcnt lgkmcnt(2)
    s_add_u32 s59, s58, 65536
    buffer_store_dwordx4 v[72:75], v138, s[28:31], s59 offen sc1
    s_waitcnt lgkmcnt(1)
    s_add_u32 s59, s58, 131072
    buffer_store_dwordx4 v[76:79], v138, s[28:31], s59 offen sc1
    s_waitcnt lgkmcnt(0)
    s_add_u32 s59, s58, 196608
    buffer_store_dwordx4 v[80:83], v138, s[28:31], s59 offen sc1
    s_mov_b32 s40, s16
    s_and_b32 s41, s17, 0xffff
    s_mov_b32 s42, 0x158000
    s_mov_b32 s43, 0x20000
    s_waitcnt vmcnt(0)
    s_barrier
    s_mov_b32 s49, 65536
    v_mov_b32 v248, 0
nretry_9:
    v_readfirstlane_b32 s78, v250
    v_readfirstlane_b32 s79, v251
    s_cmp_lg_u32 s78, 0
    s_cbranch_scc1 nok_10
    s_sub_u32 s49, s49, 1
    s_cmp_eq_u32 s49, 0
    s_cbranch_scc1 nok_10
nld_11:
    buffer_load_dwordx2 v[250:251], v248, s[96:99], 0 offen sc1
    s_waitcnt vmcnt(0)
    s_branch nretry_9
nok_10:
    s_cmp_lg_u32 s3, 0
    s_cbranch_scc1 w0skip_12
    s_lshl_b32 s48, s70, 2
    s_add_u32 s48, s48, s71
    s_lshl_b32 s48, s48, 3
    s_add_u32 s48, s48, 12582912
    v_lshl_add_u32 v248, v0, 10, s48
    s_lshl_b32 s48, s70, 9
    s_lshl_b32 s49, s71, 3
    s_add_u32 s48, s48, s49
    s_add_u32 s48, s48, 12646488
    v_lshl_add_u32 v249, v0, 8, s48
    v_cmp_gt_u32 vcc, 8, v0
    s_nop 1
    v_cndmask_b32 v248, v249, v248, vcc
    v_mov_b32 v250, s78
    v_mov_b32 v251, s79
    s_mov_b64 exec, 0x3ff
    buffer_store_dwordx2 v[250:251], v248, s[28:31], 0 offen sc1
    s_mov_b64 exec, -1
    s_branch w0j_13
w0skip_12:
    s_add_u32 m0, s68, 0
    s_add_u32 s67, s66, 0
    buffer_load_dwordx4 v240, s[40:43], s67 offen lds
    s_add_u32 m0, s68, 1024
    s_add_u32 s67, s66, 8192
    buffer_load_dwordx4 v240, s[40:43], s67 offen lds
    s_add_u32 m0, s68, 16384
    s_add_u32 s67, s66, 32768
    buffer_load_dwordx4 v240, s[40:43], s67 offen lds
    s_add_u32 m0, s68, 17408
    s_add_u32 s67, s66, 40960
    buffer_load_dwordx4 v240, s[40:43], s67 offen lds
    s_add_u32 m0, s68, 32768
    s_add_u32 s67, s66, 65536
    buffer_load_dwordx4 v240, s[40:43], s67 offen lds
    s_add_u32 m0, s68, 33792
    s_add_u32 s67, s66, 73728
    buffer_load_dwordx4 v240, s[40:43], s67 offen lds
    s_add_u32 m0, s68, 49152
    s_add_u32 s67, s66, 98304
    buffer_load_dwordx4 v240, s[40:43], s67 offen lds
    s_add_u32 m0, s68, 50176
    s_add_u32 s67, s66, 106496
    buffer_load_dwordx4 v240, s[40:43], s67 offen lds
    s_add_u32 m0, s68, 65536
    s_add_u32 s67, s66, 131072
    buffer_load_dwordx4 v240, s[40:43], s67 offen lds
    s_add_u32 m0, s68, 66560
    s_add_u32 s67, s66, 139264
    buffer_load_dwordx4 v240, s[40:43], s67 offen lds
w0j_13:
    s_branch L_p2
L_nop1:
    s_sub_u32 s50, s2, 240
    s_mul_i32 s50, s50, 688
    s_lshl_b32 s51, s3, 6
    s_add_u32 s50, s50, s51
    v_add_u32 v2, s50, v0
    v_lshlrev_b32 v2, 7, v2
    s_waitcnt lgkmcnt(0)
    s_mov_b32 s28, s26
    s_and_b32 s29, s27, 0xffff
    s_mov_b32 s30, 0x1000000
    s_mov_b32 s31, 0x20000
    s_mov_b32 s40, s16
    s_and_b32 s41, s17, 0xffff
    s_mov_b32 s42, 0x158000
    s_mov_b32 s43, 0x20000
    buffer_load_dword v241, v2, s[40:43], 0 offen
    s_cmp_ge_u32 s3, 3
    s_cbranch_scc1 t2_14
    v_add_u32 v2, 0x10000, v2
    buffer_load_dword v242, v2, s[40:43], 0 offen
t2_14:
    s_mov_b32 s96, s24
    s_and_b32 s97, s25, 0xffff
    s_mov_b32 s98, 0x100
    s_mov_b32 s99, 0x20000
    s_cmp_lg_u32 s2, 240
    s_cbranch_scc1 L_idle
    s_mov_b32 s77, 64
    v_and_b32 v16, 15, v0
    v_lshrrev_b32 v17, 4, v0
    s_mov_b32 s40, s6
    s_and_b32 s41, s7, 0xffff
    s_mov_b32 s42, 0x101000
    s_mov_b32 s43, 0x20000
    s_mov_b32 s44, s8
    s_and_b32 s45, s9, 0xffff
    s_mov_b32 s46, 0x101000
    s_mov_b32 s47, 0x20000
    v_lshlrev_b32 v4, 4, v0
    v_cmp_gt_u32 vcc, 32, v0
    s_and_b32 s53, s77, 1
    s_lshl_b32 s53, s53, 1
    s_lshl_b32 s50, s3, 1
    s_add_u32 s50, s50, 0
    s_lshl_b32 s50, s50, 7
    s_add_u32 s50, s50, s77
    s_sub_u32 s51, 2048, s50
    s_and_b32 s51, s51, 2047
    s_mul_i32 s50, s50, 514
    s_mul_i32 s51, s51, 514
    s_sub_u32 s50, s50, s53
    s_add_u32 s51, s51, s53
    s_sub_u32 s52, s51, 512
    v_mov_b32 v5, s52
    v_mov_b32 v6, s50
    v_cndmask_b32 v5, v5, v6, vcc
    v_add_u32 v5, v5, v4
    buffer_load_dwordx4 v[114:117], v5, s[40:43], 0 offen
    buffer_load_dwordx4 v[118:121], v5, s[44:47], 0 offen
    s_add_u32 s50, s50, 512
    v_mov_b32 v6, s50
    s_add_u32 s52, s51, 512
    v_writelane_b32 v6, s52, 63
    s_sub_u32 s51, s51, s53
    s_sub_u32 s51, s51, s53
    v_writelane_b32 v6, s51, 0
    s_mov_b32 exec_lo, 0x80000001
    s_mov_b32 exec_hi, 0x80000001
    buffer_load_dword v130, v6, s[40:43], 0 offen
    buffer_load_dword v131, v6, s[44:47], 0 offen
    s_mov_b64 exec, -1
    s_lshl_b32 s50, s3, 1
    s_add_u32 s50, s50, 1
    s_lshl_b32 s50, s50, 7
    s_add_u32 s50, s50, s77
    s_sub_u32 s51, 2048, s50
    s_and_b32 s51, s51, 2047
    s_mul_i32 s50, s50, 514
    s_mul_i32 s51, s51, 514
    s_sub_u32 s50, s50, s53
    s_add_u32 s51, s51, s53
    s_sub_u32 s52, s51, 512
    v_mov_b32 v5, s52
    v_mov_b32 v6, s50
    v_cndmask_b32 v5, v5, v6, vcc
    v_add_u32 v5, v5, v4
    buffer_load_dwordx4 v[122:125], v5, s[40:43], 0 offen
    buffer_load_dwordx4 v[126:129], v5, s[44:47], 0 offen
    s_add_u32 s50, s50, 512
    v_mov_b32 v6, s50
    s_add_u32 s52, s51, 512
    v_writelane_b32 v6, s52, 63
    s_sub_u32 s51, s51, s53
    s_sub_u32 s51, s51, s53
    v_writelane_b32 v6, s51, 0
    s_mov_b32 exec_lo, 0x80000001
    s_mov_b32 exec_hi, 0x80000001
    buffer_load_dword v132, v6, s[40:43], 0 offen
    buffer_load_dword v133, v6, s[44:47], 0 offen
    s_mov_b64 exec, -1
    s_mov_b32 s40, s16
    s_and_b32 s41, s17, 0xffff
    s_mov_b32 s42, 0x158000
    s_mov_b32 s43, 0x20000
    s_mov_b32 s49, 65536
    v_mov_b32 v248, 0
    s_branch nld_17
nretry_15:
    v_readfirstlane_b32 s78, v250
    v_readfirstlane_b32 s79, v251
    s_cmp_lg_u32 s78, 0
    s_cbranch_scc1 nok_16
    s_sub_u32 s49, s49, 1
    s_cmp_eq_u32 s49, 0
    s_cbranch_scc1 nok_16
nld_17:
    buffer_load_dwordx2 v[250:251], v248, s[96:99], 0 offen sc1
    s_waitcnt vmcnt(0)
    s_branch nretry_15
nok_16:
    s_waitcnt vmcnt(0)
    s_cmp_eq_u32 s3, 0
    s_cbranch_scc1 w0only_18
    s_add_u32 m0, s68, 0
    s_add_u32 s67, s66, 0
    buffer_load_dwordx4 v240, s[40:43], s67 offen lds
    s_add_u32 m0, s68, 1024
    s_add_u32 s67, s66, 8192
    buffer_load_dwordx4 v240, s[40:43], s67 offen lds
    s_add_u32 m0, s68, 16384
    s_add_u32 s67, s66, 32768
    buffer_load_dwordx4 v240, s[40:43], s67 offen lds
    s_add_u32 m0, s68, 17408
    s_add_u32 s67, s66, 40960
    buffer_load_dwordx4 v240, s[40:43], s67 offen lds
    s_add_u32 m0, s68, 32768
    s_add_u32 s67, s66, 65536
    buffer_load_dwordx4 v240, s[40:43], s67 offen lds
    s_add_u32 m0, s68, 33792
    s_add_u32 s67, s66, 73728
    buffer_load_dwordx4 v240, s[40:43], s67 offen lds
    s_add_u32 m0, s68, 49152
    s_add_u32 s67, s66, 98304
    buffer_load_dwordx4 v240, s[40:43], s67 offen lds
    s_add_u32 m0, s68, 50176
    s_add_u32 s67, s66, 106496
    buffer_load_dwordx4 v240, s[40:43], s67 offen lds
    s_add_u32 m0, s68, 65536
    s_add_u32 s67, s66, 131072
    buffer_load_dwordx4 v240, s[40:43], s67 offen lds
    s_add_u32 m0, s68, 66560
    s_add_u32 s67, s66, 139264
    buffer_load_dwordx4 v240, s[40:43], s67 offen lds
w0only_18:
L_p2:
    v_bfe_u32 v2, v0, 2, 2
    v_lshl_add_u32 v2, v17, 2, v2
    v_and_b32 v3, 7, v2
    v_lshlrev_b32 v3, 1, v3
    v_bfe_u32 v4, v0, 1, 1
    s_lshl_b32 s50, s3, 3
    v_or_b32 v4, s50, v4
    v_xor_b32 v4, v4, v3
    v_lshlrev_b32 v4, 4, v4
    v_lshl_add_u32 v4, v2, 11, v4
    v_and_b32 v5, 1, v0
    v_lshl_add_u32 v136, v5, 3, v4
    v_add_u32 v136, 114688, v136
    v_xor_b32 v137, 32, v136
    v_xor_b32 v138, 64, v136
    v_xor_b32 v139, 96, v136
    v_lshlrev_b32 v2, 13, v17
    v_lshl_add_u32 v2, v16, 4, v2
    s_lshl_b32 s50, s3, 8
    s_add_u32 s50, s50, 81920
    v_add_u32 v228, s50, v2
    s_lshl_b32 s50, s3, 12
    s_add_u32 s50, s50, 81920
    v_lshl_add_u32 v229, v0, 4, s50
    v_mul_u32_u24 v2, 4128, v17
    v_lshl_add_u32 v2, v16, 3, v2
    s_lshl_b32 s50, s3, 7
    s_add_u32 s50, s50, 114688
    v_add_u32 v230, s50, v2
    v_lshrrev_b32 v2, 3, v16
    s_lshl_b32 s50, s3, 2
    v_add_u32 v2, s50, v2
    v_mul_u32_u24 v2, 1032, v2
    v_lshl_add_u32 v2, v17, 8, v2
    v_bfe_u32 v3, v0, 2, 1
    v_lshl_add_u32 v2, v3, 6, v2
    v_and_b32 v3, 3, v0
    v_lshl_add_u32 v2, v3, 3, v2
    v_add_u32 v231, 114688, v2
    v_add_u32 v232, 116752, v2
    v_lshlrev_b32 v2, 17, v16
    v_lshl_add_u32 v2, v17, 4, v2
    s_lshl_b32 s50, s3, 7
    v_add_u32 v233, s50, v2
    v_lshrrev_b32 v2, 2, v16
    s_lshl_b32 s50, s3, 2
    v_add_u32 v2, s50, v2
    v_mul_u32_u24 v2, 1032, v2
    v_lshl_add_u32 v2, v17, 8, v2
    v_and_b32 v3, 3, v0
    v_lshl_add_u32 v2, v3, 5, v2
    v_add_u32 v231, 114688, v2
    v_lshlrev_b32 v2, 19, v17
    v_lshl_add_u32 v2, v16, 3, v2
    s_lshl_b32 s50, s3, 7
    v_add_u32 v233, s50, v2
    s_cmp_eq_u32 s3, 0
    s_cbranch_scc1 cs_end_19
    v_cvt_f32_u32 v2, v16
    v_lshlrev_b32 v3, 2, v17
    v_cvt_f32_u32 v3, v3
    s_cmp_eq_u32 s77, 64
    s_cselect_b32 s54, 0x3f800000, 0
    v_lshlrev_b32 v10, 4, v0
    v_add_u32 v10, 81920, v10
    s_cmp_eq_u32 s3, 2
    s_cbranch_scc1 cs2_20
    s_cmp_eq_u32 s3, 3
    s_cbranch_scc1 cs3_21
    s_cmp_eq_u32 s3, 4
    s_cbranch_scc1 cs4_22
    s_cmp_eq_u32 s3, 5
    s_cbranch_scc1 cs5_23
    s_cmp_eq_u32 s3, 6
    s_cbranch_scc1 cs6_24
    s_cmp_eq_u32 s3, 7
    s_cbranch_scc1 cs7_25
    v_mul_f32 v4, 0x3d000000, v2
    v_mul_f32 v5, v4, v3
    v_mov_b32 v148, v5
    v_fma_f32 v149, v4, 1.0, v5
    v_fma_f32 v150, v4, 2.0, v5
    v_fmamk_f32 v151, v4, 0x40400000, v5
    v_cos_f32 v152, v148
    v_cos_f32 v153, v149
    v_cos_f32 v154, v150
    v_cos_f32 v155, v151
    v_sin_f32 v156, v148
    v_sin_f32 v157, v149
    v_sin_f32 v158, v150
    v_sin_f32 v159, v151
    v_cvt_pk_bf16_f32 v22, v152, v153
    v_cvt_pk_bf16_f32 v23, v154, v155
    v_cvt_pk_bf16_f32 v24, v156, v157
    v_cvt_pk_bf16_f32 v25, v158, v159
    v_xor_b32 v20, 0x80008000, v24
    v_xor_b32 v21, 0x80008000, v25
    v_and_b32 v6, 1, v16
    v_mul_u32_u24 v6, 0x8000, v6
    v_lshl_or_b32 v6, v6, 16, v6
    v_xor_b32 v7, 0x80000000, v6
    v_xor_b32 v26, v6, v20
    v_xor_b32 v32, 0x80000000, v20
    v_xor_b32 v38, v7, v20
    v_xor_b32 v27, v6, v21
    v_xor_b32 v33, 0x80000000, v21
    v_xor_b32 v39, v7, v21
    v_xor_b32 v28, v6, v22
    v_xor_b32 v34, 0x80000000, v22
    v_xor_b32 v40, v7, v22
    v_xor_b32 v29, v6, v23
    v_xor_b32 v35, 0x80000000, v23
    v_xor_b32 v41, v7, v23
    v_xor_b32 v30, v6, v24
    v_xor_b32 v36, 0x80000000, v24
    v_xor_b32 v42, v7, v24
    v_xor_b32 v31, v6, v25
    v_xor_b32 v37, 0x80000000, v25
    v_xor_b32 v43, v7, v25
    ds_write_b64 v10, v[20:21] offset:0
    ds_write_b64 v10, v[22:23] offset:8
    ds_write_b64 v10, v[24:25] offset:1024
    ds_write_b64 v10, v[26:27] offset:1032
    ds_write_b64 v10, v[28:29] offset:2048
    ds_write_b64 v10, v[30:31] offset:2056
    ds_write_b64 v10, v[32:33] offset:3072
    ds_write_b64 v10, v[34:35] offset:3080
    ds_write_b64 v10, v[36:37] offset:4096
    ds_write_b64 v10, v[38:39] offset:4104
    ds_write_b64 v10, v[40:41] offset:5120
    ds_write_b64 v10, v[42:43] offset:5128
    s_branch cs_end_19
cs2_20:
    v_mul_f32 v4, 0x3d800000, v2
    v_mul_f32 v5, v4, v3
    v_mov_b32 v148, v5
    v_fma_f32 v149, v4, 1.0, v5
    v_fma_f32 v150, v4, 2.0, v5
    v_fmamk_f32 v151, v4, 0x40400000, v5
    v_cos_f32 v152, v148
    v_cos_f32 v153, v149
    v_cos_f32 v154, v150
    v_cos_f32 v155, v151
    v_sin_f32 v156, v148
    v_sin_f32 v157, v149
    v_sin_f32 v158, v150
    v_sin_f32 v159, v151
    v_cvt_pk_bf16_f32 v46, v152, v153
    v_cvt_pk_bf16_f32 v47, v154, v155
    v_cvt_pk_bf16_f32 v48, v156, v157
    v_cvt_pk_bf16_f32 v49, v158, v159
    v_xor_b32 v44, 0x80008000, v48
    v_xor_b32 v45, 0x80008000, v49
    ds_write_b64 v10, v[44:45] offset:6144
    ds_write_b64 v10, v[46:47] offset:6152
    ds_write_b64 v10, v[48:49] offset:7168
    v_fma_f32 v4, v2, 2.0, s54
    v_mul_f32 v4, 0x3d000000, v4
    v_mul_f32 v5, v4, v3
    v_mov_b32 v148, v5
    v_fma_f32 v149, v4, 1.0, v5
    v_fma_f32 v150, v4, 2.0, v5
    v_fmamk_f32 v151, v4, 0x40400000, v5
    v_cos_f32 v152, v148
    v_cos_f32 v153, v149
    v_cos_f32 v154, v150
    v_cos_f32 v155, v151
    v_sin_f32 v156, v148
    v_sin_f32 v157, v149
    v_sin_f32 v158, v150
    v_sin_f32 v159, v151
    v_cvt_pk_bf16_f32 v160, v152, v153
    v_cvt_pk_bf16_f32 v161, v154, v155
    v_cvt_pk_bf16_f32 v162, v156, v157
    v_cvt_pk_bf16_f32 v163, v158, v159
    v_xor_b32 v164, 0x80008000, v162
    v_xor_b32 v165, 0x80008000, v163
    s_cmp_eq_u32 s77, 0
    s_cbranch_scc1 a1_0_26
    s_cmp_eq_u32 s77, 64
    s_cbranch_scc1 a1_64_27
    v_mov_b32 v50, v160
    v_mov_b32 v51, v161
    v_mov_b32 v52, v162
    v_mov_b32 v53, v163
    v_mov_b32 v54, v164
    v_mov_b32 v55, v165
    v_mov_b32 v56, v160
    v_mov_b32 v57, v161
    s_branch a1_j_28
a1_0_26:
    v_mov_b32 v50, v160
    v_mov_b32 v51, v161
    v_mov_b32 v52, 0
    v_mov_b32 v53, 0
    v_mov_b32 v54, v164
    v_mov_b32 v55, v165
    v_mov_b32 v56, 0
    v_mov_b32 v57, 0
    s_branch a1_j_28
a1_64_27:
    v_mov_b32 v50, 0
    v_mov_b32 v51, 0
    v_mov_b32 v52, v160
    v_mov_b32 v53, v161
    v_mov_b32 v54, 0
    v_mov_b32 v55, 0
    v_mov_b32 v56, v164
    v_mov_b32 v57, v165
a1_j_28:
    ds_write_b64 v10, v[50:51] offset:7176
    ds_write_b64 v10, v[52:53] offset:8192
    ds_write_b64 v10, v[54:55] offset:8200
    ds_write_b64 v10, v[56:57] offset:9216
    s_branch cs_end_19
cs3_21:
    v_mul_f32 v4, 0x3d800000, v2
    v_mul_f32 v5, s54, v2
    v_mul_f32 v5, 0x3d000000, v5
    v_fmac_f32 v5, v4, v3
    v_mov_b32 v148, v5
    v_fma_f32 v149, v4, 1.0, v5
    v_fma_f32 v150, v4, 2.0, v5
    v_fmamk_f32 v151, v4, 0x40400000, v5
    v_cos_f32 v152, v148
    v_cos_f32 v153, v149
    v_cos_f32 v154, v150
    v_cos_f32 v155, v151
    v_sin_f32 v156, v148
    v_sin_f32 v157, v149
    v_sin_f32 v158, v150
    v_sin_f32 v159, v151
    v_cvt_pk_bf16_f32 v58, v152, v153
    v_cvt_pk_bf16_f32 v60, v154, v155
    v_cvt_pk_bf16_f32 v59, v156, v157
    v_cvt_pk_bf16_f32 v61, v158, v159
    v_mov_b32 v62, v59
    v_xor_b32 v63, 0x80008000, v58
    v_mov_b32 v64, v61
    v_xor_b32 v65, 0x80008000, v60
    ds_write_b64 v10, v[58:59] offset:9224
    ds_write_b64 v10, v[60:61] offset:10240
    ds_write_b64 v10, v[62:63] offset:10248
    ds_write_b64 v10, v[64:65] offset:11264
    s_branch cs_end_19
cs4_22:
    v_mov_b32 v4, v2
    v_mul_f32 v4, 0x3b000000, v4
    v_mul_f32 v5, v4, v3
    v_mov_b32 v148, v5
    v_fma_f32 v149, v4, 1.0, v5
    v_fma_f32 v150, v4, 2.0, v5
    v_fmamk_f32 v151, v4, 0x40400000, v5
    v_cos_f32 v66, v148
    v_cos_f32 v67, v149
    v_cos_f32 v68, v150
    v_cos_f32 v69, v151
    v_sin_f32 v74, v148
    v_sin_f32 v75, v149
    v_sin_f32 v76, v150
    v_sin_f32 v77, v151
    ds_write_b64 v10, v[66:67] offset:11272
    ds_write_b64 v10, v[68:69] offset:12288
    ds_write_b64 v10, v[74:75] offset:13320
    ds_write_b64 v10, v[76:77] offset:14336
    s_branch cs_end_19
cs5_23:
    v_add_f32 v4, 0x41800000, v2
    v_mul_f32 v4, 0x3b000000, v4
    v_mul_f32 v5, v4, v3
    v_mov_b32 v148, v5
    v_fma_f32 v149, v4, 1.0, v5
    v_fma_f32 v150, v4, 2.0, v5
    v_fmamk_f32 v151, v4, 0x40400000, v5
    v_cos_f32 v70, v148
    v_cos_f32 v71, v149
    v_cos_f32 v72, v150
    v_cos_f32 v73, v151
    v_sin_f32 v78, v148
    v_sin_f32 v79, v149
    v_sin_f32 v80, v150
    v_sin_f32 v81, v151
    ds_write_b64 v10, v[70:71] offset:12296
    ds_write_b64 v10, v[72:73] offset:13312
    ds_write_b64 v10, v[78:79] offset:14344
    ds_write_b64 v10, v[80:81] offset:15360
    s_branch cs_end_19
cs6_24:
    s_and_b32 s55, s77, 63
    s_cmp_eq_u32 s55, 0
    s_mov_b32 s56, 0x36000000
    s_cselect_b32 s55, 0x35800000, s56
    v_mul_f32 v4, 0x3b000000, v2
    v_mov_b32 v5, v3
    v_mul_f32 v5, v5, v4
    v_mov_b32 v148, v5
    v_fma_f32 v149, v4, 1.0, v5
    v_fma_f32 v150, v4, 2.0, v5
    v_fmamk_f32 v151, v4, 0x40400000, v5
    v_cos_f32 v152, v148
    v_cos_f32 v153, v149
    v_cos_f32 v154, v150
    v_cos_f32 v155, v151
    v_sin_f32 v156, v148
    v_sin_f32 v157, v149
    v_sin_f32 v158, v150
    v_sin_f32 v159, v151
    v_mul_f32 v82, s55, v152
    v_mul_f32 v83, s55, v153
    v_mul_f32 v84, s55, v154
    v_mul_f32 v85, s55, v155
    v_mul_f32 v90, s55, v156
    v_mul_f32 v91, s55, v157
    v_mul_f32 v92, s55, v158
    v_mul_f32 v93, s55, v159
    ds_write_b64 v10, v[82:83] offset:15368
    ds_write_b64 v10, v[84:85] offset:16384
    ds_write_b64 v10, v[90:91] offset:17416
    ds_write_b64 v10, v[92:93] offset:18432
    s_branch cs_end_19
cs7_25:
    s_and_b32 s55, s77, 63
    s_cmp_eq_u32 s55, 0
    s_mov_b32 s56, 0x36000000
    s_cselect_b32 s55, 0x35800000, s56
    v_mul_f32 v4, 0x3b000000, v2
    v_add_f32 v5, 0x41800000, v3
    v_mul_f32 v5, v5, v4
    v_mov_b32 v148, v5
    v_fma_f32 v149, v4, 1.0, v5
    v_fma_f32 v150, v4, 2.0, v5
    v_fmamk_f32 v151, v4, 0x40400000, v5
    v_cos_f32 v152, v148
    v_cos_f32 v153, v149
    v_cos_f32 v154, v150
    v_cos_f32 v155, v151
    v_sin_f32 v156, v148
    v_sin_f32 v157, v149
    v_sin_f32 v158, v150
    v_sin_f32 v159, v151
    v_mul_f32 v86, s55, v152
    v_mul_f32 v87, s55, v153
    v_mul_f32 v88, s55, v154
    v_mul_f32 v89, s55, v155
    v_mul_f32 v94, s55, v156
    v_mul_f32 v95, s55, v157
    v_mul_f32 v96, s55, v158
    v_mul_f32 v97, s55, v159
    ds_write_b64 v10, v[86:87] offset:16392
    ds_write_b64 v10, v[88:89] offset:17408
    ds_write_b64 v10, v[94:95] offset:18440
    ds_write_b64 v10, v[96:97] offset:19456
cs_end_19:
    s_cmp_eq_u32 s3, 0
    s_cbranch_scc1 w0only_29
    s_waitcnt vmcnt(10)
    s_mul_i32 s50, s3, 1152
    s_add_u32 s50, s50, 149504
    s_and_b32 s51, s77, 1
    v_cmp_gt_u32 vcc, 32, v0
    v_mov_b32 v2, 64
    s_nop 0
    v_cndmask_b32 v2, v2, 0, vcc
    v_lshl_add_u32 v2, v0, 4, v2
    v_add_u32 v2, s50, v2
    v_bfe_u32 v3, v0, 2, 2
    v_lshlrev_b32 v3, 6, v3
    v_lshl_add_u32 v3, v17, 8, v3
    v_sub_u32 v4, 1568, v3
    v_cndmask_b32 v3, v4, v3, vcc
    v_and_b32 v4, 3, v0
    v_lshl_add_u32 v3, v4, 3, v3
    v_add_u32 v3, s50, v3
    v_mov_b32 v4, -32
    v_mov_b32 v5, 32
    v_cndmask_b32 v4, v4, v5, vcc
    v_add_u32 v4, v3, v4
    s_lshl_b32 s52, s51, 4
    s_xor_b32 s53, s52, 16
    v_mov_b32 v5, s53
    v_mov_b32 v6, s52
    v_cndmask_b32 v5, v5, v6, vcc
    v_and_b32 v6, 31, v0
    v_cmp_eq_u32 s[62:63], 31, v6
    v_mov_b32_dpp v6, v114 wave_shl:1 row_mask:0xf bank_mask:0xf
    s_nop 0
    v_cndmask_b32 v6, v6, v130, s[62:63]
    v_alignbit_b32 v114, v115, v114, v5
    v_alignbit_b32 v115, v116, v115, v5
    v_alignbit_b32 v116, v117, v116, v5
    v_alignbit_b32 v117, v6, v117, v5
    ds_write_b128 v2, v[114:117]
    ds_read_b64_tr_b16 v[148:149], v3
    ds_read_b64_tr_b16 v[150:151], v4
    v_mov_b32_dpp v6, v118 wave_shl:1 row_mask:0xf bank_mask:0xf
    v_cndmask_b32 v6, v6, v131, s[62:63]
    v_alignbit_b32 v118, v119, v118, v5
    v_alignbit_b32 v119, v120, v119, v5
    v_alignbit_b32 v120, v121, v120, v5
    v_alignbit_b32 v121, v6, v121, v5
    ds_write_b128 v2, v[118:121]
    ds_read_b64_tr_b16 v[152:153], v3
    ds_read_b64_tr_b16 v[154:155], v4
    v_mov_b32_dpp v6, v122 wave_shl:1 row_mask:0xf bank_mask:0xf
    v_cndmask_b32 v6, v6, v132, s[62:63]
    v_alignbit_b32 v122, v123, v122, v5
    v_alignbit_b32 v123, v124, v123, v5
    v_alignbit_b32 v124, v125, v124, v5
    v_alignbit_b32 v125, v6, v125, v5
    ds_write_b128 v2, v[122:125]
    ds_read_b64_tr_b16 v[156:157], v3
    ds_read_b64_tr_b16 v[158:159], v4
    v_mov_b32_dpp v6, v126 wave_shl:1 row_mask:0xf bank_mask:0xf
    v_cndmask_b32 v6, v6, v133, s[62:63]
    v_alignbit_b32 v126, v127, v126, v5
    v_alignbit_b32 v127, v128, v127, v5
    v_alignbit_b32 v128, v129, v128, v5
    v_alignbit_b32 v129, v6, v129, v5
    ds_write_b128 v2, v[126:129]
    ds_read_b64_tr_b16 v[160:161], v3
    ds_read_b64_tr_b16 v[162:163], v4
    v_mov_b32 v6, 0x80008000
    v_cndmask_b32 v6, v6, 0, vcc
    v_mov_b32 v7, 0xffff0000
    v_mov_b32 v8, 0x80000000
    v_cndmask_b32 v8, 0, v8, vcc
    v_lshlrev_b32 v130, s53, v130
    v_and_b32 v130, v7, v130
    v_lshlrev_b32 v131, s53, v131
    v_and_b32 v131, v7, v131
    v_lshlrev_b32 v132, s53, v132
    v_and_b32 v132, v7, v132
    v_lshlrev_b32 v133, s53, v133
    v_and_b32 v133, v7, v133
    v_xor_b32 v131, v131, v8
    v_xor_b32 v133, v133, v8
    s_waitcnt lgkmcnt(6)
    v_mov_b32_dpp v148, v148 row_mirror row_mask:0xc bank_mask:0xf
    v_mov_b32_dpp v149, v149 row_mirror row_mask:0xc bank_mask:0xf
    v_mov_b32_dpp v150, v150 row_mirror row_mask:0xc bank_mask:0xf
    v_mov_b32_dpp v151, v151 row_mirror row_mask:0xc bank_mask:0xf
    v_mov_b32_dpp v152, v152 row_mirror row_mask:0xc bank_mask:0xf
    v_mov_b32_dpp v153, v153 row_mirror row_mask:0xc bank_mask:0xf
    v_mov_b32_dpp v154, v154 row_mirror row_mask:0xc bank_mask:0xf
    v_mov_b32_dpp v155, v155 row_mirror row_mask:0xc bank_mask:0xf
    v_xor_b32 v152, v152, v6
    v_xor_b32 v153, v153, v6
    v_xor_b32 v154, v154, v6
    v_xor_b32 v155, v155, v6
    v_lshlrev_b32 v98, 16, v148
    v_and_b32 v99, v7, v148
    v_lshlrev_b32 v100, 16, v149
    v_and_b32 v101, v7, v149
    v_lshlrev_b32 v106, 16, v150
    v_and_b32 v107, v7, v150
    v_lshlrev_b32 v108, 16, v151
    v_and_b32 v109, v7, v151
    v_lshlrev_b32 v102, 16, v152
    v_and_b32 v103, v7, v152
    v_lshlrev_b32 v104, 16, v153
    v_and_b32 v105, v7, v153
    v_lshlrev_b32 v110, 16, v154
    v_and_b32 v111, v7, v154
    v_lshlrev_b32 v112, 16, v155
    v_and_b32 v113, v7, v155
    s_waitcnt lgkmcnt(0)
    v_mov_b32_dpp v156, v156 row_mirror row_mask:0xc bank_mask:0xf
    v_mov_b32_dpp v157, v157 row_mirror row_mask:0xc bank_mask:0xf
    v_mov_b32_dpp v158, v158 row_mirror row_mask:0xc bank_mask:0xf
    v_mov_b32_dpp v159, v159 row_mirror row_mask:0xc bank_mask:0xf
    v_mov_b32_dpp v160, v160 row_mirror row_mask:0xc bank_mask:0xf
    v_mov_b32_dpp v161, v161 row_mirror row_mask:0xc bank_mask:0xf
    v_mov_b32_dpp v162, v162 row_mirror row_mask:0xc bank_mask:0xf
    v_mov_b32_dpp v163, v163 row_mirror row_mask:0xc bank_mask:0xf
    v_xor_b32 v160, v160, v6
    v_xor_b32 v161, v161, v6
    v_xor_b32 v162, v162, v6
    v_xor_b32 v163, v163, v6
    v_lshlrev_b32 v114, 16, v156
    v_and_b32 v115, v7, v156
    v_lshlrev_b32 v116, 16, v157
    v_and_b32 v117, v7, v157
    v_lshlrev_b32 v122, 16, v158
    v_and_b32 v123, v7, v158
    v_lshlrev_b32 v124, 16, v159
    v_and_b32 v125, v7, v159
    v_lshlrev_b32 v118, 16, v160
    v_and_b32 v119, v7, v160
    v_lshlrev_b32 v120, 16, v161
    v_and_b32 v121, v7, v161
    v_lshlrev_b32 v126, 16, v162
    v_and_b32 v127, v7, v162
    v_lshlrev_b32 v128, 16, v163
    v_and_b32 v129, v7, v163
    s_mov_b32 exec_lo, 1
    s_mov_b32 exec_hi, 1
    v_add_f32 v98, v98, v130
    v_add_f32 v102, v102, v131
    v_mul_f32 v98, 0.5, v98
    v_mul_f32 v102, 0.5, v102
    v_add_f32 v114, v114, v132
    v_add_f32 v118, v118, v133
    v_mul_f32 v114, 0.5, v114
    v_mul_f32 v118, 0.5, v118
    s_mov_b64 exec, -1
w0only_29:
    s_waitcnt lgkmcnt(0)
    s_cmp_lg_u32 s3, 0
    s_cbranch_scc1 w0skip_30
    s_mul_i32 s50, s3, 1152
    s_add_u32 s50, s50, 149504
    s_and_b32 s51, s77, 1
    v_cmp_gt_u32 vcc, 32, v0
    v_mov_b32 v2, 64
    s_nop 0
    v_cndmask_b32 v2, v2, 0, vcc
    v_lshl_add_u32 v2, v0, 4, v2
    v_add_u32 v2, s50, v2
    v_bfe_u32 v3, v0, 2, 2
    v_lshlrev_b32 v3, 6, v3
    v_lshl_add_u32 v3, v17, 8, v3
    v_sub_u32 v4, 1568, v3
    v_cndmask_b32 v3, v4, v3, vcc
    v_and_b32 v4, 3, v0
    v_lshl_add_u32 v3, v4, 3, v3
    v_add_u32 v3, s50, v3
    v_mov_b32 v4, -32
    v_mov_b32 v5, 32
    v_cndmask_b32 v4, v4, v5, vcc
    v_add_u32 v4, v3, v4
    s_lshl_b32 s52, s51, 4
    s_xor_b32 s53, s52, 16
    v_mov_b32 v5, s53
    v_mov_b32 v6, s52
    v_cndmask_b32 v5, v5, v6, vcc
    v_and_b32 v6, 31, v0
    v_cmp_eq_u32 s[62:63], 31, v6
    v_mov_b32_dpp v6, v114 wave_shl:1 row_mask:0xf bank_mask:0xf
    s_nop 0
    v_cndmask_b32 v6, v6, v130, s[62:63]
    v_alignbit_b32 v114, v115, v114, v5
    v_alignbit_b32 v115, v116, v115, v5
    v_alignbit_b32 v116, v117, v116, v5
    v_alignbit_b32 v117, v6, v117, v5
    ds_write_b128 v2, v[114:117]
    ds_read_b64_tr_b16 v[148:149], v3
    ds_read_b64_tr_b16 v[150:151], v4
    v_mov_b32_dpp v6, v118 wave_shl:1 row_mask:0xf bank_mask:0xf
    v_cndmask_b32 v6, v6, v131, s[62:63]
    v_alignbit_b32 v118, v119, v118, v5
    v_alignbit_b32 v119, v120, v119, v5
    v_alignbit_b32 v120, v121, v120, v5
    v_alignbit_b32 v121, v6, v121, v5
    ds_write_b128 v2, v[118:121]
    ds_read_b64_tr_b16 v[152:153], v3
    ds_read_b64_tr_b16 v[154:155], v4
    v_mov_b32_dpp v6, v122 wave_shl:1 row_mask:0xf bank_mask:0xf
    v_cndmask_b32 v6, v6, v132, s[62:63]
    v_alignbit_b32 v122, v123, v122, v5
    v_alignbit_b32 v123, v124, v123, v5
    v_alignbit_b32 v124, v125, v124, v5
    v_alignbit_b32 v125, v6, v125, v5
    ds_write_b128 v2, v[122:125]
    ds_read_b64_tr_b16 v[156:157], v3
    ds_read_b64_tr_b16 v[158:159], v4
    v_mov_b32_dpp v6, v126 wave_shl:1 row_mask:0xf bank_mask:0xf
    v_cndmask_b32 v6, v6, v133, s[62:63]
    v_alignbit_b32 v126, v127, v126, v5
    v_alignbit_b32 v127, v128, v127, v5
    v_alignbit_b32 v128, v129, v128, v5
    v_alignbit_b32 v129, v6, v129, v5
    ds_write_b128 v2, v[126:129]
    ds_read_b64_tr_b16 v[160:161], v3
    ds_read_b64_tr_b16 v[162:163], v4
    v_mov_b32 v6, 0x80008000
    v_cndmask_b32 v6, v6, 0, vcc
    v_mov_b32 v7, 0xffff0000
    v_mov_b32 v8, 0x80000000
    v_cndmask_b32 v8, 0, v8, vcc
    v_lshlrev_b32 v130, s53, v130
    v_and_b32 v130, v7, v130
    v_lshlrev_b32 v131, s53, v131
    v_and_b32 v131, v7, v131
    v_lshlrev_b32 v132, s53, v132
    v_and_b32 v132, v7, v132
    v_lshlrev_b32 v133, s53, v133
    v_and_b32 v133, v7, v133
    v_xor_b32 v131, v131, v8
    v_xor_b32 v133, v133, v8
    s_waitcnt lgkmcnt(6)
    v_mov_b32_dpp v148, v148 row_mirror row_mask:0xc bank_mask:0xf
    v_mov_b32_dpp v149, v149 row_mirror row_mask:0xc bank_mask:0xf
    v_mov_b32_dpp v150, v150 row_mirror row_mask:0xc bank_mask:0xf
    v_mov_b32_dpp v151, v151 row_mirror row_mask:0xc bank_mask:0xf
    v_mov_b32_dpp v152, v152 row_mirror row_mask:0xc bank_mask:0xf
    v_mov_b32_dpp v153, v153 row_mirror row_mask:0xc bank_mask:0xf
    v_mov_b32_dpp v154, v154 row_mirror row_mask:0xc bank_mask:0xf
    v_mov_b32_dpp v155, v155 row_mirror row_mask:0xc bank_mask:0xf
    v_xor_b32 v152, v152, v6
    v_xor_b32 v153, v153, v6
    v_xor_b32 v154, v154, v6
    v_xor_b32 v155, v155, v6
    v_lshlrev_b32 v98, 16, v148
    v_and_b32 v99, v7, v148
    v_lshlrev_b32 v100, 16, v149
    v_and_b32 v101, v7, v149
    v_lshlrev_b32 v106, 16, v150
    v_and_b32 v107, v7, v150
    v_lshlrev_b32 v108, 16, v151
    v_and_b32 v109, v7, v151
    v_lshlrev_b32 v102, 16, v152
    v_and_b32 v103, v7, v152
    v_lshlrev_b32 v104, 16, v153
    v_and_b32 v105, v7, v153
    v_lshlrev_b32 v110, 16, v154
    v_and_b32 v111, v7, v154
    v_lshlrev_b32 v112, 16, v155
    v_and_b32 v113, v7, v155
    s_waitcnt lgkmcnt(0)
    v_mov_b32_dpp v156, v156 row_mirror row_mask:0xc bank_mask:0xf
    v_mov_b32_dpp v157, v157 row_mirror row_mask:0xc bank_mask:0xf
    v_mov_b32_dpp v158, v158 row_mirror row_mask:0xc bank_mask:0xf
    v_mov_b32_dpp v159, v159 row_mirror row_mask:0xc bank_mask:0xf
    v_mov_b32_dpp v160, v160 row_mirror row_mask:0xc bank_mask:0xf
    v_mov_b32_dpp v161, v161 row_mirror row_mask:0xc bank_mask:0xf
    v_mov_b32_dpp v162, v162 row_mirror row_mask:0xc bank_mask:0xf
    v_mov_b32_dpp v163, v163 row_mirror row_mask:0xc bank_mask:0xf
    v_xor_b32 v160, v160, v6
    v_xor_b32 v161, v161, v6
    v_xor_b32 v162, v162, v6
    v_xor_b32 v163, v163, v6
    v_lshlrev_b32 v114, 16, v156
    v_and_b32 v115, v7, v156
    v_lshlrev_b32 v116, 16, v157
    v_and_b32 v117, v7, v157
    v_lshlrev_b32 v122, 16, v158
    v_and_b32 v123, v7, v158
    v_lshlrev_b32 v124, 16, v159
    v_and_b32 v125, v7, v159
    v_lshlrev_b32 v118, 16, v160
    v_and_b32 v119, v7, v160
    v_lshlrev_b32 v120, 16, v161
    v_and_b32 v121, v7, v161
    v_lshlrev_b32 v126, 16, v162
    v_and_b32 v127, v7, v162
    v_lshlrev_b32 v128, 16, v163
    v_and_b32 v129, v7, v163
    s_mov_b32 exec_lo, 1
    s_mov_b32 exec_hi, 1
    v_add_f32 v98, v98, v130
    v_add_f32 v102, v102, v131
    v_mul_f32 v98, 0.5, v98
    v_mul_f32 v102, 0.5, v102
    v_add_f32 v114, v114, v132
    v_add_f32 v118, v118, v133
    v_mul_f32 v114, 0.5, v114
    v_mul_f32 v118, 0.5, v118
    s_mov_b64 exec, -1
w0skip_30:
    s_cmp_lg_u32 s3, 0
    s_cbranch_scc1 w0skip_31
    s_lshl_b32 s49, s72, 10
    s_add_u32 s49, s49, 12582912
    v_lshlrev_b32 v248, 3, v0
    s_mov_b32 s48, 65536
poll_32:
    buffer_load_dwordx2 v[250:251], v248, s[28:31], s49 offen sc1
    s_waitcnt vmcnt(0)
    v_cmp_eq_u32 vcc, s78, v250
    v_cmp_eq_u32 s[50:51], s79, v251
    s_nop 0
    s_and_b64 vcc, vcc, s[50:51]
    s_cmp_eq_u64 vcc, exec
    s_cbranch_scc1 w0skip_31
    s_sub_u32 s48, s48, 1
    s_cmp_lg_u32 s48, 0
    s_cbranch_scc1 poll_32
w0skip_31:
    s_barrier
    s_and_b32 s50, s77, 63
    s_lshl_b32 s50, s50, 15
    s_add_u32 s50, s50, 6291456
    s_lshl_b32 s51, s3, 12
    s_add_u32 s50, s50, s51
    s_add_u32 s51, s51, 114688
    s_lshl_b32 s52, s3, 1
    s_add_u32 s52, s52, 0
    s_and_b32 s52, s52, 7
    s_lshl_b32 s52, s52, 1
    v_xor_b32 v134, s52, v0
    v_lshlrev_b32 v134, 4, v134
    s_lshl_b32 s52, s3, 1
    s_add_u32 s52, s52, 1
    s_and_b32 s52, s52, 7
    s_lshl_b32 s52, s52, 1
    v_xor_b32 v135, s52, v0
    v_lshlrev_b32 v135, 4, v135
    s_add_u32 m0, s51, 0
    s_add_u32 s53, s50, 0
    buffer_load_dwordx4 v134, s[28:31], s53 offen lds
    s_add_u32 m0, s51, 1024
    s_add_u32 s53, s50, 1024
    buffer_load_dwordx4 v134, s[28:31], s53 offen lds
    s_add_u32 m0, s51, 2048
    s_add_u32 s53, s50, 2048
    buffer_load_dwordx4 v135, s[28:31], s53 offen lds
    s_add_u32 m0, s51, 3072
    s_add_u32 s53, s50, 3072
    buffer_load_dwordx4 v135, s[28:31], s53 offen lds
    v_lshlrev_b32 v10, 4, v0
    v_add_u32 v10, 81920, v10
    ds_read_b128 v[20:23], v10 offset:0
    ds_read_b128 v[24:27], v10 offset:1024
    ds_read_b128 v[28:31], v10 offset:2048
    ds_read_b128 v[32:35], v10 offset:3072
    ds_read_b128 v[36:39], v10 offset:4096
    ds_read_b128 v[40:43], v10 offset:5120
    ds_read_b128 v[44:47], v10 offset:6144
    ds_read_b128 v[48:51], v10 offset:7168
    ds_read_b128 v[52:55], v10 offset:8192
    ds_read_b128 v[56:59], v10 offset:9216
    ds_read_b128 v[60:63], v10 offset:10240
    ds_read_b128 v[64:67], v10 offset:11264
    ds_read_b128 v[68:71], v10 offset:12288
    ds_read_b128 v[72:75], v10 offset:13312
    ds_read_b128 v[76:79], v10 offset:14336
    ds_read_b128 v[80:83], v10 offset:15360
    ds_read_b128 v[84:87], v10 offset:16384
    ds_read_b128 v[88:91], v10 offset:17408
    ds_read_b128 v[92:95], v10 offset:18432
    ds_read_b64 v[96:97], v10 offset:19456
    s_waitcnt lgkmcnt(0)
    s_waitcnt vmcnt(0)
    s_barrier
    ds_read_b64_tr_b16 v[148:149], v136 offset:0
    ds_read_b64_tr_b16 v[150:151], v136 offset:1024
    ds_read_b64_tr_b16 v[152:153], v137 offset:0
    ds_read_b64_tr_b16 v[154:155], v137 offset:1024
    ds_read_b64_tr_b16 v[156:157], v138 offset:0
    ds_read_b64_tr_b16 v[158:159], v138 offset:1024
    ds_read_b64_tr_b16 v[160:161], v139 offset:0
    ds_read_b64_tr_b16 v[162:163], v139 offset:1024
    s_waitcnt lgkmcnt(6)
    v_mfma_f32_16x16x32_bf16 v[164:167], v[50:53], v[148:151], 0
    v_mfma_f32_16x16x32_bf16 v[168:171], v[54:57], v[148:151], 0
    s_waitcnt lgkmcnt(4)
    v_mfma_f32_16x16x32_bf16 v[172:175], v[50:53], v[152:155], 0
    v_mfma_f32_16x16x32_bf16 v[176:179], v[54:57], v[152:155], 0
    s_waitcnt lgkmcnt(2)
    v_mfma_f32_16x16x32_bf16 v[180:183], v[50:53], v[156:159], 0
    v_mfma_f32_16x16x32_bf16 v[184:187], v[54:57], v[156:159], 0
    s_waitcnt lgkmcnt(0)
    v_mfma_f32_16x16x32_bf16 v[188:191], v[50:53], v[160:163], 0
    v_mfma_f32_16x16x32_bf16 v[192:195], v[54:57], v[160:163], 0
    s_nop 0
    v_cvt_pk_bf16_f32 v196, v164, v172
    s_nop 4
    v_cvt_pk_bf16_f32 v197, v180, v188
    v_cvt_pk_bf16_f32 v198, v168, v176
    v_cvt_pk_bf16_f32 v199, v184, v192
    ds_write_b128 v228, v[196:199] offset:0
    v_cvt_pk_bf16_f32 v200, v165, v173
    v_cvt_pk_bf16_f32 v201, v181, v189
    v_cvt_pk_bf16_f32 v202, v169, v177
    v_cvt_pk_bf16_f32 v203, v185, v193
    ds_write_b128 v228, v[200:203] offset:2048
    v_cvt_pk_bf16_f32 v204, v166, v174
    v_cvt_pk_bf16_f32 v205, v182, v190
    v_cvt_pk_bf16_f32 v206, v170, v178
    v_cvt_pk_bf16_f32 v207, v186, v194
    ds_write_b128 v228, v[204:207] offset:4096
    v_cvt_pk_bf16_f32 v208, v167, v175
    v_cvt_pk_bf16_f32 v209, v183, v191
    v_cvt_pk_bf16_f32 v210, v171, v179
    v_cvt_pk_bf16_f32 v211, v187, v195
    ds_write_b128 v228, v[208:211] offset:6144
    s_waitcnt lgkmcnt(0)
    s_barrier
    ds_read_b128 v[148:151], v229 offset:0
    ds_read_b128 v[152:155], v229 offset:1024
    ds_read_b128 v[156:159], v229 offset:2048
    ds_read_b128 v[160:163], v229 offset:3072
    s_cmp_lg_u32 s3, 0
    s_cbranch_scc1 w0skip_33
    s_add_u32 m0, s68, 0
    s_add_u32 s67, s66, 0
    buffer_load_dwordx4 v240, s[40:43], s67 offen lds
    s_add_u32 m0, s68, 1024
    s_add_u32 s67, s66, 8192
    buffer_load_dwordx4 v240, s[40:43], s67 offen lds
    s_add_u32 m0, s68, 16384
    s_add_u32 s67, s66, 32768
    buffer_load_dwordx4 v240, s[40:43], s67 offen lds
    s_add_u32 m0, s68, 17408
    s_add_u32 s67, s66, 40960
    buffer_load_dwordx4 v240, s[40:43], s67 offen lds
    s_add_u32 m0, s68, 32768
    s_add_u32 s67, s66, 65536
    buffer_load_dwordx4 v240, s[40:43], s67 offen lds
    s_add_u32 m0, s68, 33792
    s_add_u32 s67, s66, 73728
    buffer_load_dwordx4 v240, s[40:43], s67 offen lds
    s_add_u32 m0, s68, 49152
    s_add_u32 s67, s66, 98304
    buffer_load_dwordx4 v240, s[40:43], s67 offen lds
    s_add_u32 m0, s68, 50176
    s_add_u32 s67, s66, 106496
    buffer_load_dwordx4 v240, s[40:43], s67 offen lds
    s_add_u32 m0, s68, 65536
    s_add_u32 s67, s66, 131072
    buffer_load_dwordx4 v240, s[40:43], s67 offen lds
    s_add_u32 m0, s68, 66560
    s_add_u32 s67, s66, 139264
    buffer_load_dwordx4 v240, s[40:43], s67 offen lds
w0skip_33:
    s_lshl_b32 s61, s74, 1
    s_add_u32 s61, s61, s75
    s_lshl_b32 s61, s61, 8
    s_add_u32 s61, s61, 12648448
    v_min_u32 v248, 14, v0
    v_lshlrev_b32 v248, 3, v248
    buffer_load_dwordx2 v[250:251], v248, s[28:31], s61 offen sc1
    s_waitcnt lgkmcnt(2)
    v_mfma_f32_16x16x32_bf16 v[164:167], v[148:151], v[22:25], 0
    v_mfma_f32_16x16x32_bf16 v[168:171], v[148:151], v[20:23], 0
    v_mfma_f32_16x16x32_bf16 v[172:175], v[148:151], v[34:37], 0
    v_mfma_f32_16x16x32_bf16 v[176:179], v[148:151], v[32:35], 0
    v_mfma_f32_16x16x32_bf16 v[164:167], v[152:155], v[28:31], v[164:167]
    v_mfma_f32_16x16x32_bf16 v[168:171], v[152:155], v[26:29], v[168:171]
    v_mfma_f32_16x16x32_bf16 v[172:175], v[152:155], v[40:43], v[172:175]
    v_mfma_f32_16x16x32_bf16 v[176:179], v[152:155], v[38:41], v[176:179]
    s_waitcnt lgkmcnt(0)
    v_mfma_f32_16x16x32_bf16 v[180:183], v[156:159], v[22:25], 0
    s_nop 2
    v_mul_f32 v212, v164, v66
    v_mul_f32 v213, v165, v67
    v_mul_f32 v214, v166, v68
    v_mul_f32 v215, v167, v69
    v_mul_f32 v216, v168, v66
    v_mfma_f32_16x16x32_bf16 v[184:187], v[156:159], v[20:23], 0
    v_mul_f32 v217, v169, v67
    v_mul_f32 v218, v170, v68
    v_mul_f32 v219, v171, v69
    v_fmac_f32 v212, v168, v74
    v_fmac_f32 v213, v169, v75
    v_mfma_f32_16x16x32_bf16 v[188:191], v[156:159], v[34:37], 0
    v_fmac_f32 v214, v170, v76
    v_fmac_f32 v215, v171, v77
    v_fma_f32 v216, -v164, v74, v216
    v_fma_f32 v217, -v165, v75, v217
    v_fma_f32 v218, -v166, v76, v218
    v_mfma_f32_16x16x32_bf16 v[192:195], v[156:159], v[32:35], 0
    v_fma_f32 v219, -v167, v77, v219
    v_cvt_pk_bf16_f32 v196, v212, v213
    v_cvt_pk_bf16_f32 v197, v214, v215
    v_cvt_pk_bf16_f32 v198, v216, v217
    v_cvt_pk_bf16_f32 v199, v218, v219
    v_mfma_f32_16x16x32_bf16 v[180:183], v[160:163], v[28:31], v[180:183]
    v_mul_f32 v220, v172, v70
    v_mul_f32 v221, v173, v71
    v_mul_f32 v222, v174, v72
    v_mul_f32 v223, v175, v73
    v_mul_f32 v224, v176, v70
    v_mfma_f32_16x16x32_bf16 v[184:187], v[160:163], v[26:29], v[184:187]
    v_mul_f32 v225, v177, v71
    v_mul_f32 v226, v178, v72
    v_mul_f32 v227, v179, v73
    v_fmac_f32 v220, v176, v78
    v_fmac_f32 v221, v177, v79
    v_mfma_f32_16x16x32_bf16 v[188:191], v[160:163], v[40:43], v[188:191]
    v_fmac_f32 v222, v178, v80
    v_fmac_f32 v223, v179, v81
    v_fma_f32 v224, -v172, v78, v224
    v_fma_f32 v225, -v173, v79, v225
    v_fma_f32 v226, -v174, v80, v226
    v_mfma_f32_16x16x32_bf16 v[192:195], v[160:163], v[38:41], v[192:195]
    v_fma_f32 v227, -v175, v81, v227
    v_cvt_pk_bf16_f32 v200, v220, v221
    v_cvt_pk_bf16_f32 v201, v222, v223
    v_cvt_pk_bf16_f32 v202, v224, v225
    v_cvt_pk_bf16_f32 v203, v226, v227
    v_mfma_f32_16x16x32_bf16 v[164:167], v[46:49], v[196:199], 0
    v_mul_f32 v212, v180, v66
    v_mul_f32 v213, v181, v67
    v_mul_f32 v214, v182, v68
    v_mul_f32 v215, v183, v69
    v_mul_f32 v216, v184, v66
    v_mul_f32 v217, v185, v67
    v_mul_f32 v218, v186, v68
    v_mul_f32 v219, v187, v69
    v_fmac_f32 v212, v184, v74
    v_fmac_f32 v213, v185, v75
    v_mfma_f32_16x16x32_bf16 v[168:171], v[44:47], v[196:199], 0
    v_fmac_f32 v214, v186, v76
    v_fmac_f32 v215, v187, v77
    v_fma_f32 v216, -v180, v74, v216
    v_fma_f32 v217, -v181, v75, v217
    v_fma_f32 v218, -v182, v76, v218
    v_fma_f32 v219, -v183, v77, v219
    v_cvt_pk_bf16_f32 v204, v212, v213
    v_cvt_pk_bf16_f32 v205, v214, v215
    v_cvt_pk_bf16_f32 v206, v216, v217
    v_cvt_pk_bf16_f32 v207, v218, v219
    v_mfma_f32_16x16x32_bf16 v[172:175], v[46:49], v[200:203], 0
    v_mul_f32 v220, v188, v70
    v_mul_f32 v221, v189, v71
    v_mul_f32 v222, v190, v72
    v_mul_f32 v223, v191, v73
    v_mul_f32 v224, v192, v70
    v_mul_f32 v225, v193, v71
    v_mul_f32 v226, v194, v72
    v_mul_f32 v227, v195, v73
    v_fmac_f32 v220, v192, v78
    v_fmac_f32 v221, v193, v79
    v_mfma_f32_16x16x32_bf16 v[176:179], v[44:47], v[200:203], 0
    v_fmac_f32 v222, v194, v80
    v_fmac_f32 v223, v195, v81
    v_fma_f32 v224, -v188, v78, v224
    v_fma_f32 v225, -v189, v79, v225
    v_fma_f32 v226, -v190, v80, v226
    v_fma_f32 v227, -v191, v81, v227
    v_cvt_pk_bf16_f32 v208, v220, v221
    v_cvt_pk_bf16_f32 v209, v222, v223
    v_cvt_pk_bf16_f32 v210, v224, v225
    v_cvt_pk_bf16_f32 v211, v226, v227
    v_mfma_f32_16x16x32_bf16 v[180:183], v[46:49], v[204:207], 0
    v_mul_f32 v212, v164, v98
    v_mul_f32 v213, v165, v99
    v_mul_f32 v214, v166, v100
    v_mul_f32 v215, v167, v101
    v_mul_f32_e64 v216, -v164, v102
    v_mul_f32_e64 v217, -v165, v103
    v_mul_f32_e64 v218, -v166, v104
    v_mul_f32_e64 v219, -v167, v105
    v_fma_f32 v212, -v168, v102, v212
    v_fma_f32 v213, -v169, v103, v213
    v_mfma_f32_16x16x32_bf16 v[184:187], v[44:47], v[204:207], 0
    v_fma_f32 v214, -v170, v104, v214
    v_fma_f32 v215, -v171, v105, v215
    v_fma_f32 v216, -v168, v98, v216
    v_fma_f32 v217, -v169, v99, v217
    v_fma_f32 v218, -v170, v100, v218
    v_fma_f32 v219, -v171, v101, v219
    v_cvt_pk_bf16_f32 v196, v212, v213
    v_cvt_pk_bf16_f32 v197, v214, v215
    v_cvt_pk_bf16_f32 v198, v216, v217
    v_cvt_pk_bf16_f32 v199, v218, v219
    v_mfma_f32_16x16x32_bf16 v[188:191], v[46:49], v[208:211], 0
    v_mul_f32 v220, v172, v106
    v_mul_f32 v221, v173, v107
    v_mul_f32 v222, v174, v108
    v_mul_f32 v223, v175, v109
    v_mul_f32_e64 v224, -v172, v110
    v_mul_f32_e64 v225, -v173, v111
    v_mul_f32_e64 v226, -v174, v112
    v_mul_f32_e64 v227, -v175, v113
    v_fma_f32 v220, -v176, v110, v220
    v_fma_f32 v221, -v177, v111, v221
    v_mfma_f32_16x16x32_bf16 v[192:195], v[44:47], v[208:211], 0
    v_fma_f32 v222, -v178, v112, v222
    v_fma_f32 v223, -v179, v113, v223
    v_fma_f32 v224, -v176, v106, v224
    v_fma_f32 v225, -v177, v107, v225
    v_fma_f32 v226, -v178, v108, v226
    v_fma_f32 v227, -v179, v109, v227
    v_cvt_pk_bf16_f32 v200, v220, v221
    v_cvt_pk_bf16_f32 v201, v222, v223
    v_cvt_pk_bf16_f32 v202, v224, v225
    v_cvt_pk_bf16_f32 v203, v226, v227
    v_mfma_f32_16x16x32_bf16 v[164:167], v[196:199], v[46:49], 0
    v_mul_f32 v212, v180, v114
    v_mul_f32 v213, v181, v115
    v_mul_f32 v214, v182, v116
    v_mul_f32 v215, v183, v117
    v_mul_f32_e64 v216, -v180, v118
    v_mul_f32_e64 v217, -v181, v119
    v_mul_f32_e64 v218, -v182, v120
    v_mul_f32_e64 v219, -v183, v121
    v_fma_f32 v212, -v184, v118, v212
    v_fma_f32 v213, -v185, v119, v213
    v_mfma_f32_16x16x32_bf16 v[168:171], v[196:199], v[44:47], 0
    v_fma_f32 v214, -v186, v120, v214
    v_fma_f32 v215, -v187, v121, v215
    v_fma_f32 v216, -v184, v114, v216
    v_fma_f32 v217, -v185, v115, v217
    v_fma_f32 v218, -v186, v116, v218
    v_fma_f32 v219, -v187, v117, v219
    v_cvt_pk_bf16_f32 v204, v212, v213
    v_cvt_pk_bf16_f32 v205, v214, v215
    v_cvt_pk_bf16_f32 v206, v216, v217
    v_cvt_pk_bf16_f32 v207, v218, v219
    v_mfma_f32_16x16x32_bf16 v[172:175], v[200:203], v[46:49], 0
    v_mul_f32 v220, v188, v122
    v_mul_f32 v221, v189, v123
    v_mul_f32 v222, v190, v124
    v_mul_f32 v223, v191, v125
    v_mul_f32_e64 v224, -v188, v126
    v_mul_f32_e64 v225, -v189, v127
    v_mul_f32_e64 v226, -v190, v128
    v_mul_f32_e64 v227, -v191, v129
    v_fma_f32 v220, -v192, v126, v220
    v_fma_f32 v221, -v193, v127, v221
    v_mfma_f32_16x16x32_bf16 v[176:179], v[200:203], v[44:47], 0
    v_fma_f32 v222, -v194, v128, v222
    v_fma_f32 v223, -v195, v129, v223
    v_fma_f32 v224, -v192, v122, v224
    v_fma_f32 v225, -v193, v123, v225
    v_fma_f32 v226, -v194, v124, v226
    v_fma_f32 v227, -v195, v125, v227
    v_cvt_pk_bf16_f32 v208, v220, v221
    v_cvt_pk_bf16_f32 v209, v222, v223
    v_cvt_pk_bf16_f32 v210, v224, v225
    v_cvt_pk_bf16_f32 v211, v226, v227
    s_mov_b32 s60, 65536
fchk_34:
    s_waitcnt vmcnt(0)
    v_cmp_eq_u32 vcc, s78, v250
    v_cmp_eq_u32 s[62:63], s79, v251
    s_nop 0
    s_and_b64 vcc, vcc, s[62:63]
    s_cmp_eq_u64 vcc, exec
    s_cbranch_scc1 fok_35
    s_sub_u32 s60, s60, 1
    s_cmp_eq_u32 s60, 0
    s_cbranch_scc1 fok_35
    buffer_load_dwordx2 v[250:251], v248, s[28:31], s61 offen sc1
    s_branch fchk_34
fok_35:
    v_lshlrev_b32 v19, 4, v0
    s_mul_i32 s70, s74, 352256
    s_lshl_b32 s71, s75, 1
    s_add_u32 s71, s71, s64
    s_mul_i32 s71, s71, 88064
    s_add_u32 s70, s70, s71
    s_mul_i32 s71, s65, 22528
    s_add_u32 s70, s70, s71
    s_add_u32 s71, s70, 0
    buffer_load_dwordx4 v[104:107], v19, s[28:31], s71 offen offset:0
    buffer_load_dwordx4 v[108:111], v19, s[28:31], s71 offen offset:1024
    s_add_u32 s71, s70, 2048
    buffer_load_dwordx4 v[112:115], v19, s[28:31], s71 offen offset:0
    buffer_load_dwordx4 v[116:119], v19, s[28:31], s71 offen offset:1024
    s_add_u32 s71, s70, 4096
    buffer_load_dwordx4 v[120:123], v19, s[28:31], s71 offen offset:0
    buffer_load_dwordx4 v[124:127], v19, s[28:31], s71 offen offset:1024
    v_mfma_f32_16x16x32_bf16 v[180:183], v[204:207], v[46:49], 0
    v_mul_f32 v212, v164, v82
    v_mul_f32 v213, v165, v83
    v_mul_f32 v214, v166, v84
    v_mul_f32 v215, v167, v85
    v_mul_f32 v216, v168, v82
    v_mul_f32 v217, v169, v83
    v_mul_f32 v218, v170, v84
    v_mul_f32 v219, v171, v85
    v_fmac_f32 v212, v168, v90
    v_fmac_f32 v213, v169, v91
    v_mfma_f32_16x16x32_bf16 v[184:187], v[204:207], v[44:47], 0
    v_fmac_f32 v214, v170, v92
    v_fmac_f32 v215, v171, v93
    v_fma_f32 v216, -v164, v90, v216
    v_fma_f32 v217, -v165, v91, v217
    v_fma_f32 v218, -v166, v92, v218
    v_fma_f32 v219, -v167, v93, v219
    v_cvt_pk_bf16_f32 v196, v212, v213
    v_cvt_pk_bf16_f32 v197, v214, v215
    v_cvt_pk_bf16_f32 v198, v216, v217
    v_cvt_pk_bf16_f32 v199, v218, v219
    v_mfma_f32_16x16x32_bf16 v[188:191], v[208:211], v[46:49], 0
    v_mul_f32 v220, v172, v86
    v_mul_f32 v221, v173, v87
    v_mul_f32 v222, v174, v88
    v_mul_f32 v223, v175, v89
    v_mul_f32 v224, v176, v86
    v_mul_f32 v225, v177, v87
    v_mul_f32 v226, v178, v88
    v_mul_f32 v227, v179, v89
    v_fmac_f32 v220, v176, v94
    v_fmac_f32 v221, v177, v95
    v_mfma_f32_16x16x32_bf16 v[192:195], v[208:211], v[44:47], 0
    v_fmac_f32 v222, v178, v96
    v_fmac_f32 v223, v179, v97
    v_fma_f32 v224, -v172, v94, v224
    v_fma_f32 v225, -v173, v95, v225
    v_fma_f32 v226, -v174, v96, v226
    v_fma_f32 v227, -v175, v97, v227
    v_cvt_pk_bf16_f32 v200, v220, v221
    v_cvt_pk_bf16_f32 v201, v222, v223
    v_cvt_pk_bf16_f32 v202, v224, v225
    v_cvt_pk_bf16_f32 v203, v226, v227
    s_add_u32 s71, s70, 6144
    buffer_load_dwordx4 v[128:131], v19, s[28:31], s71 offen offset:0
    buffer_load_dwordx4 v[132:135], v19, s[28:31], s71 offen offset:1024
    s_add_u32 s71, s70, 8192
    buffer_load_dwordx4 v[136:139], v19, s[28:31], s71 offen offset:0
    buffer_load_dwordx4 v[140:143], v19, s[28:31], s71 offen offset:1024
    v_mfma_f32_16x16x32_bf16 v[164:167], v[22:25], v[196:199], 0
    v_mul_f32 v212, v180, v82
    v_mul_f32 v213, v181, v83
    v_mul_f32 v214, v182, v84
    v_mul_f32 v215, v183, v85
    v_mul_f32 v216, v184, v82
    v_mfma_f32_16x16x32_bf16 v[168:171], v[20:23], v[196:199], 0
    v_mul_f32 v217, v185, v83
    v_mul_f32 v218, v186, v84
    v_mul_f32 v219, v187, v85
    v_fmac_f32 v212, v184, v90
    v_fmac_f32 v213, v185, v91
    v_mfma_f32_16x16x32_bf16 v[172:175], v[34:37], v[196:199], 0
    v_fmac_f32 v214, v186, v92
    v_fmac_f32 v215, v187, v93
    v_fma_f32 v216, -v180, v90, v216
    v_fma_f32 v217, -v181, v91, v217
    v_fma_f32 v218, -v182, v92, v218
    v_mfma_f32_16x16x32_bf16 v[176:179], v[32:35], v[196:199], 0
    v_fma_f32 v219, -v183, v93, v219
    v_cvt_pk_bf16_f32 v204, v212, v213
    v_cvt_pk_bf16_f32 v205, v214, v215
    v_cvt_pk_bf16_f32 v206, v216, v217
    v_cvt_pk_bf16_f32 v207, v218, v219
    v_mfma_f32_16x16x32_bf16 v[164:167], v[28:31], v[200:203], v[164:167]
    v_mul_f32 v220, v188, v86
    v_mul_f32 v221, v189, v87
    v_mul_f32 v222, v190, v88
    v_mul_f32 v223, v191, v89
    v_mul_f32 v224, v192, v86
    v_mfma_f32_16x16x32_bf16 v[168:171], v[26:29], v[200:203], v[168:171]
    v_mul_f32 v225, v193, v87
    v_mul_f32 v226, v194, v88
    v_mul_f32 v227, v195, v89
    v_fmac_f32 v220, v192, v94
    v_fmac_f32 v221, v193, v95
    v_mfma_f32_16x16x32_bf16 v[172:175], v[40:43], v[200:203], v[172:175]
    v_fmac_f32 v222, v194, v96
    v_fmac_f32 v223, v195, v97
    v_fma_f32 v224, -v188, v94, v224
    v_fma_f32 v225, -v189, v95, v225
    v_fma_f32 v226, -v190, v96, v226
    v_mfma_f32_16x16x32_bf16 v[176:179], v[38:41], v[200:203], v[176:179]
    v_fma_f32 v227, -v191, v97, v227
    v_cvt_pk_bf16_f32 v208, v220, v221
    v_cvt_pk_bf16_f32 v209, v222, v223
    v_cvt_pk_bf16_f32 v210, v224, v225
    v_cvt_pk_bf16_f32 v211, v226, v227
    s_add_u32 s71, s70, 10240
    buffer_load_dwordx4 v[212:215], v19, s[28:31], s71 offen offset:0
    buffer_load_dwordx4 v[216:219], v19, s[28:31], s71 offen offset:1024
    s_add_u32 s71, s70, 12288
    buffer_load_dwordx4 v[220:223], v19, s[28:31], s71 offen offset:0
    buffer_load_dwordx4 v[224:227], v19, s[28:31], s71 offen offset:1024
    v_mfma_f32_16x16x32_bf16 v[180:183], v[22:25], v[204:207], 0
    v_mfma_f32_16x16x32_bf16 v[184:187], v[20:23], v[204:207], 0
    v_mfma_f32_16x16x32_bf16 v[188:191], v[34:37], v[204:207], 0
    v_mfma_f32_16x16x32_bf16 v[192:195], v[32:35], v[204:207], 0
    v_mfma_f32_16x16x32_bf16 v[180:183], v[28:31], v[208:211], v[180:183]
    v_mfma_f32_16x16x32_bf16 v[184:187], v[26:29], v[208:211], v[184:187]
    v_mfma_f32_16x16x32_bf16 v[188:191], v[40:43], v[208:211], v[188:191]
    v_mfma_f32_16x16x32_bf16 v[192:195], v[38:41], v[208:211], v[192:195]
    s_nop 4
    v_cvt_pk_bf16_f32 v196, v164, v180
    v_cvt_pk_bf16_f32 v197, v168, v184
    ds_write_b64 v230, v[196:197] offset:0
    v_cvt_pk_bf16_f32 v198, v165, v181
    v_cvt_pk_bf16_f32 v199, v169, v185
    ds_write_b64 v230, v[198:199] offset:1032
    v_cvt_pk_bf16_f32 v200, v166, v182
    v_cvt_pk_bf16_f32 v201, v170, v186
    ds_write_b64 v230, v[200:201] offset:2064
    v_cvt_pk_bf16_f32 v202, v167, v183
    v_cvt_pk_bf16_f32 v203, v171, v187
    ds_write_b64 v230, v[202:203] offset:3096
    v_cvt_pk_bf16_f32 v204, v172, v188
    v_cvt_pk_bf16_f32 v205, v176, v192
    ds_write_b64 v230, v[204:205] offset:16512
    v_cvt_pk_bf16_f32 v206, v173, v189
    v_cvt_pk_bf16_f32 v207, v177, v193
    ds_write_b64 v230, v[206:207] offset:17544
    v_cvt_pk_bf16_f32 v208, v174, v190
    v_cvt_pk_bf16_f32 v209, v178, v194
    ds_write_b64 v230, v[208:209] offset:18576
    v_cvt_pk_bf16_f32 v210, v175, v191
    v_cvt_pk_bf16_f32 v211, v179, v195
    ds_write_b64 v230, v[210:211] offset:19608
    v_bfe_u32 v2, v0, 2, 2
    v_lshrrev_b32 v3, 5, v0
    v_lshl_add_u32 v3, v3, 2, v2
    v_lshlrev_b32 v3, 7, v3
    v_bfe_u32 v4, v0, 4, 1
    v_and_b32 v5, 1, v0
    v_lshl_add_u32 v4, v4, 1, v5
    v_bfe_u32 v5, v0, 3, 1
    v_lshl_add_u32 v4, v5, 2, v4
    v_lshl_add_u32 v3, v4, 4, v3
    v_bfe_u32 v5, v0, 1, 1
    v_lshl_add_u32 v3, v5, 3, v3
    s_lshl_b32 s67, s65, 12
    v_add_u32 v20, s67, v3
    v_xor_b32 v21, 64, v20
    v_add_u32 v22, 65536, v20
    v_add_u32 v23, 65536, v21
    v_add_u32 v24, 131072, v20
    v_add_u32 v25, 131072, v21
    v_lshlrev_b32 v19, 4, v0
    s_mul_i32 s67, s64, 24576
    s_add_u32 s67, s67, 32768
    v_add_u32 v26, s67, v19
    s_mul_i32 s69, s65, 6144
    v_add_u32 v27, s69, v26
    s_lshl_b32 s69, s75, 6
    s_lshl_b32 s67, s64, 5
    s_add_u32 s69, s69, s67
    v_and_b32 v2, 31, v0
    v_add_u32 v2, s69, v2
    v_lshlrev_b32 v34, 2, v2
    v_lshlrev_b32 v3, 4, v2
    v_add_u32 v3, s74, v3
    v_cvt_f32_u32 v29, v3
    v_lshlrev_b32 v3, 10, v3
    v_lshrrev_b32 v4, 5, v0
    v_lshlrev_b32 v4, 4, v4
    s_lshl_b32 s67, s76, 7
    s_lshl_b32 s69, s65, 5
    s_add_u32 s67, s67, s69
    v_add_u32 v4, s67, v4
    v_add_u32 v28, v3, v4
    v_mov_b32 v30, v4
    s_waitcnt lgkmcnt(0)
    s_barrier
    ds_read2_b64 v[148:151], v231 offset0:0 offset1:16
    ds_read2_b64 v[152:155], v231 offset0:1 offset1:17
    ds_read2_b64 v[156:159], v231 offset0:2 offset1:18
    ds_read2_b64 v[160:163], v231 offset0:3 offset1:19
    s_lshl_b32 s67, s74, 9
    s_add_u32 s67, s67, 10485760
    v_mov_b32 v2, v34
    buffer_load_dword v34, v2, s[28:31], s67 offen
    s_add_u32 s67, s67, 8192
    buffer_load_dword v35, v2, s[28:31], s67 offen
    s_add_u32 s67, s67, 8192
    buffer_load_dword v36, v2, s[28:31], s67 offen
    s_add_u32 s67, s67, 8192
    buffer_load_dword v37, v2, s[28:31], s67 offen
    s_add_u32 m0, s68, 81920
    s_add_u32 s67, s66, 163840
    buffer_load_dwordx4 v240, s[40:43], s67 offen lds
    s_add_u32 m0, s68, 82944
    s_add_u32 s67, s66, 172032
    buffer_load_dwordx4 v240, s[40:43], s67 offen lds
    s_add_u32 m0, s68, 98304
    s_add_u32 s67, s66, 196608
    buffer_load_dwordx4 v240, s[40:43], s67 offen lds
    s_add_u32 m0, s68, 99328
    s_add_u32 s67, s66, 204800
    buffer_load_dwordx4 v240, s[40:43], s67 offen lds
    s_and_b32 s52, s77, 63
    s_lshl_b32 s50, s52, 11
    s_lshr_b32 s51, s77, 6
    s_lshl_b32 s51, s51, 10
    s_add_u32 s50, s50, s51
    s_add_u32 s50, s50, 8388608
    s_cmp_eq_u32 s52, 0
    s_cselect_b32 s51, 13631488, s50
    s_waitcnt lgkmcnt(3)
    v_mfma_f32_16x16x32_bf16 v[164:167], v[58:61], v[148:151], 0
    v_mfma_f32_16x16x32_bf16 v[168:171], v[62:65], v[148:151], 0
    s_waitcnt lgkmcnt(2)
    v_mfma_f32_16x16x32_bf16 v[172:175], v[58:61], v[152:155], 0
    v_mfma_f32_16x16x32_bf16 v[176:179], v[62:65], v[152:155], 0
    s_waitcnt lgkmcnt(1)
    v_mfma_f32_16x16x32_bf16 v[180:183], v[58:61], v[156:159], 0
    v_mfma_f32_16x16x32_bf16 v[184:187], v[62:65], v[156:159], 0
    s_waitcnt lgkmcnt(0)
    v_mfma_f32_16x16x32_bf16 v[188:191], v[58:61], v[160:163], 0
    v_mfma_f32_16x16x32_bf16 v[192:195], v[62:65], v[160:163], 0
    s_barrier
    v_cvt_pk_bf16_f32 v196, v164, v172
    s_nop 4
    v_cvt_pk_bf16_f32 v197, v180, v188
    buffer_store_dwordx2 v[196:197], v233, s[28:31], s50 offen offset:0 sc1
    v_cvt_pk_bf16_f32 v198, v168, v176
    v_cvt_pk_bf16_f32 v199, v184, v192
    buffer_store_dwordx2 v[198:199], v233, s[28:31], s51 offen offset:1024 sc1
    v_cvt_pk_bf16_f32 v200, v165, v173
    v_cvt_pk_bf16_f32 v201, v181, v189
    s_add_u32 s52, s50, 131072
    buffer_store_dwordx2 v[200:201], v233, s[28:31], s52 offen offset:0 sc1
    v_cvt_pk_bf16_f32 v202, v169, v177
    v_cvt_pk_bf16_f32 v203, v185, v193
    s_add_u32 s53, s51, 131072
    buffer_store_dwordx2 v[202:203], v233, s[28:31], s53 offen offset:1024 sc1
    v_cvt_pk_bf16_f32 v204, v166, v174
    v_cvt_pk_bf16_f32 v205, v182, v190
    s_add_u32 s52, s50, 262144
    buffer_store_dwordx2 v[204:205], v233, s[28:31], s52 offen offset:0 sc1
    v_cvt_pk_bf16_f32 v206, v170, v178
    v_cvt_pk_bf16_f32 v207, v186, v194
    s_add_u32 s53, s51, 262144
    buffer_store_dwordx2 v[206:207], v233, s[28:31], s53 offen offset:1024 sc1
    v_cvt_pk_bf16_f32 v208, v167, v175
    v_cvt_pk_bf16_f32 v209, v183, v191
    s_add_u32 s52, s50, 393216
    buffer_store_dwordx2 v[208:209], v233, s[28:31], s52 offen offset:0 sc1
    v_cvt_pk_bf16_f32 v210, v171, v179
    v_cvt_pk_bf16_f32 v211, v187, v195
    s_add_u32 s53, s51, 393216
    buffer_store_dwordx2 v[210:211], v233, s[28:31], s53 offen offset:1024 sc1
    s_waitcnt vmcnt(12)
    v_add_f32 v34, v34, v35
    v_add_f32 v36, v36, v37
    v_add_f32 v34, v34, v36
    v_mul_f32 v34, 0xbfb8aa3b, v34
    v_exp_f32 v34, v34
    s_nop 0
    v_add_f32 v34, 1.0, v34
    v_rcp_f32 v16, v34
    s_nop 0
    v_sub_f32 v17, 1.0, v16
    v_mul_f32 v2, 0x3a000000, v29
    v_lshrrev_b32 v3, 5, v0
    v_lshlrev_b32 v3, 1, v3
    s_lshl_b32 s67, s65, 4
    v_add_u32 v3, s67, v3
    v_cvt_f32_u32 v3, v3
    v_mul_f32 v3, v3, v2
    v_sub_f32 v4, 0, v16
    v_mov_b32 v6, v3
    v_fmamk_f32 v7, v2, 0x3f800000, v3
    v_fmamk_f32 v8, v2, 0x40800000, v3
    v_fmamk_f32 v9, v2, 0x40a00000, v3
    v_fmamk_f32 v10, v2, 0x41000000, v3
    v_fmamk_f32 v11, v2, 0x41100000, v3
    v_fmamk_f32 v12, v2, 0x41400000, v3
    v_fmamk_f32 v13, v2, 0x41500000, v3
    v_cos_f32 v192, v6
    v_cos_f32 v193, v7
    v_cos_f32 v194, v8
    v_cos_f32 v195, v9
    v_cos_f32 v196, v10
    v_cos_f32 v197, v11
    v_cos_f32 v198, v12
    v_cos_f32 v199, v13
    v_sin_f32 v200, v6
    v_sin_f32 v201, v7
    v_sin_f32 v202, v8
    v_sin_f32 v203, v9
    v_sin_f32 v204, v10
    v_sin_f32 v205, v11
    v_sin_f32 v206, v12
    v_sin_f32 v207, v13
    v_mul_f32 v192, v16, v192
    v_mul_f32 v193, v16, v193
    v_mul_f32 v194, v16, v194
    v_mul_f32 v195, v16, v195
    v_mul_f32 v196, v16, v196
    v_mul_f32 v197, v16, v197
    v_mul_f32 v198, v16, v198
    v_mul_f32 v199, v16, v199
    v_mul_f32 v200, v4, v200
    v_mul_f32 v201, v4, v201
    v_mul_f32 v202, v4, v202
    v_mul_f32 v203, v4, v203
    v_mul_f32 v204, v4, v204
    v_mul_f32 v205, v4, v205
    v_mul_f32 v206, v4, v206
    v_mul_f32 v207, v4, v207
    s_cmp_lg_u32 s65, 0
    s_cbranch_scc1 nosp_36
    v_lshlrev_b32 v5, 31, v0
    v_xor_b32 v5, v5, v16
    v_cmp_gt_u32 vcc, 32, v0
    s_nop 1
    v_cndmask_b32 v200, v200, v5, vcc
nosp_36:
    v_cvt_pk_bf16_f32 v40, v192, v200
    v_cvt_pk_bf16_f32 v41, v193, v201
    v_cvt_pk_bf16_f32 v42, v194, v202
    v_cvt_pk_bf16_f32 v43, v195, v203
    v_cvt_pk_bf16_f32 v44, v196, v204
    v_cvt_pk_bf16_f32 v45, v197, v205
    v_cvt_pk_bf16_f32 v46, v198, v206
    v_cvt_pk_bf16_f32 v47, v199, v207
    ds_read_b64_tr_b16 v[48:49], v20 offset:0
    ds_read_b64_tr_b16 v[50:51], v20 offset:1024
    ds_read_b64_tr_b16 v[52:53], v21 offset:0
    ds_read_b64_tr_b16 v[54:55], v21 offset:1024
    ds_read_b64_tr_b16 v[56:57], v20 offset:2048
    ds_read_b64_tr_b16 v[58:59], v20 offset:3072
    ds_read_b64_tr_b16 v[60:61], v21 offset:2048
    ds_read_b64_tr_b16 v[62:63], v21 offset:3072
    ds_read_b64_tr_b16 v[64:65], v20 offset:16384
    ds_read_b64_tr_b16 v[66:67], v20 offset:17408
    ds_read_b64_tr_b16 v[68:69], v21 offset:16384
    ds_read_b64_tr_b16 v[70:71], v21 offset:17408
    s_waitcnt lgkmcnt(8)
    v_mfma_f32_32x32x16_bf16 v[72:87], v[48:51], v[104:107], 0
    v_mfma_f32_32x32x16_bf16 v[88:103], v[52:55], v[104:107], 0
    ds_read_b64_tr_b16 v[48:49], v20 offset:18432
    ds_read_b64_tr_b16 v[50:51], v20 offset:19456
    ds_read_b64_tr_b16 v[52:53], v21 offset:18432
    ds_read_b64_tr_b16 v[54:55], v21 offset:19456
    s_waitcnt lgkmcnt(8)
    v_mfma_f32_32x32x16_bf16 v[72:87], v[56:59], v[108:111], v[72:87]
    v_mfma_f32_32x32x16_bf16 v[88:103], v[60:63], v[108:111], v[88:103]
    ds_read_b64_tr_b16 v[56:57], v20 offset:32768
    ds_read_b64_tr_b16 v[58:59], v20 offset:33792
    ds_read_b64_tr_b16 v[60:61], v21 offset:32768
    ds_read_b64_tr_b16 v[62:63], v21 offset:33792
    s_waitcnt lgkmcnt(8)
    v_mfma_f32_32x32x16_bf16 v[72:87], v[64:67], v[112:115], v[72:87]
    v_mfma_f32_32x32x16_bf16 v[88:103], v[68:71], v[112:115], v[88:103]
    ds_read_b64_tr_b16 v[64:65], v20 offset:34816
    ds_read_b64_tr_b16 v[66:67], v20 offset:35840
    ds_read_b64_tr_b16 v[68:69], v21 offset:34816
    ds_read_b64_tr_b16 v[70:71], v21 offset:35840
    s_waitcnt lgkmcnt(8)
    v_mfma_f32_32x32x16_bf16 v[72:87], v[48:51], v[116:119], v[72:87]
    v_mfma_f32_32x32x16_bf16 v[88:103], v[52:55], v[116:119], v[88:103]
    s_add_u32 m0, s68, 114688
    s_add_u32 s67, s66, 229376
    buffer_load_dwordx4 v240, s[40:43], s67 offen lds
    s_add_u32 m0, s68, 115712
    s_add_u32 s67, s66, 237568
    buffer_load_dwordx4 v240, s[40:43], s67 offen lds
    s_add_u32 s71, s70, 14336
    buffer_load_dwordx4 v[160:163], v19, s[28:31], s71 offen offset:0
    buffer_load_dwordx4 v[164:167], v19, s[28:31], s71 offen offset:1024
    ds_read_b64_tr_b16 v[48:49], v20 offset:49152
    ds_read_b64_tr_b16 v[50:51], v20 offset:50176
    ds_read_b64_tr_b16 v[52:53], v21 offset:49152
    ds_read_b64_tr_b16 v[54:55], v21 offset:50176
    s_waitcnt lgkmcnt(8)
    v_mfma_f32_32x32x16_bf16 v[72:87], v[56:59], v[120:123], v[72:87]
    v_mfma_f32_32x32x16_bf16 v[88:103], v[60:63], v[120:123], v[88:103]
    ds_read_b64_tr_b16 v[56:57], v20 offset:51200
    ds_read_b64_tr_b16 v[58:59], v20 offset:52224
    ds_read_b64_tr_b16 v[60:61], v21 offset:51200
    ds_read_b64_tr_b16 v[62:63], v21 offset:52224
    s_waitcnt lgkmcnt(8)
    v_mfma_f32_32x32x16_bf16 v[72:87], v[64:67], v[124:127], v[72:87]
    v_mfma_f32_32x32x16_bf16 v[88:103], v[68:71], v[124:127], v[88:103]
    ds_read_b64_tr_b16 v[64:65], v22 offset:0
    ds_read_b64_tr_b16 v[66:67], v22 offset:1024
    ds_read_b64_tr_b16 v[68:69], v23 offset:0
    ds_read_b64_tr_b16 v[70:71], v23 offset:1024
    s_waitcnt lgkmcnt(8)
    v_mfma_f32_32x32x16_bf16 v[72:87], v[48:51], v[128:131], v[72:87]
    v_mfma_f32_32x32x16_bf16 v[88:103], v[52:55], v[128:131], v[88:103]
    s_add_u32 m0, s68, 131072
    s_add_u32 s67, s66, 262144
    buffer_load_dwordx4 v240, s[40:43], s67 offen lds
    s_add_u32 m0, s68, 132096
    s_add_u32 s67, s66, 270336
    buffer_load_dwordx4 v240, s[40:43], s67 offen lds
    s_add_u32 s71, s70, 16384
    buffer_load_dwordx4 v[168:171], v19, s[28:31], s71 offen offset:0
    buffer_load_dwordx4 v[172:175], v19, s[28:31], s71 offen offset:1024
    ds_read_b64_tr_b16 v[48:49], v22 offset:2048
    ds_read_b64_tr_b16 v[50:51], v22 offset:3072
    ds_read_b64_tr_b16 v[52:53], v23 offset:2048
    ds_read_b64_tr_b16 v[54:55], v23 offset:3072
    s_waitcnt lgkmcnt(8)
    v_mfma_f32_32x32x16_bf16 v[72:87], v[56:59], v[132:135], v[72:87]
    v_mfma_f32_32x32x16_bf16 v[88:103], v[60:63], v[132:135], v[88:103]
    s_waitcnt lgkmcnt(4)
    v_mfma_f32_32x32x16_bf16 v[72:87], v[64:67], v[136:139], v[72:87]
    v_mfma_f32_32x32x16_bf16 v[88:103], v[68:71], v[136:139], v[88:103]
    s_waitcnt lgkmcnt(0)
    v_mfma_f32_32x32x16_bf16 v[72:87], v[48:51], v[140:143], v[72:87]
    v_mfma_f32_32x32x16_bf16 v[88:103], v[52:55], v[140:143], v[88:103]
    s_add_u32 m0, s68, 147456
    s_add_u32 s67, s66, 294912
    buffer_load_dwordx4 v240, s[40:43], s67 offen lds
    s_add_u32 m0, s68, 148480
    s_add_u32 s67, s66, 303104
    buffer_load_dwordx4 v240, s[40:43], s67 offen lds
    s_add_u32 s71, s70, 18432
    buffer_load_dwordx4 v[176:179], v19, s[28:31], s71 offen offset:0
    buffer_load_dwordx4 v[180:183], v19, s[28:31], s71 offen offset:1024
    s_waitcnt vmcnt(12)
    s_barrier
    s_cmp_lg_u32 s3, 0
    s_cbranch_scc1 w0skip_37
    s_lshl_b32 s48, s77, 3
    s_add_u32 s48, s48, 12599296
    v_lshl_add_u32 v248, v0, 10, s48
    v_mov_b32 v250, s78
    v_mov_b32 v251, s79
    s_mov_b64 exec, 0xffffffff
    buffer_store_dwordx2 v[250:251], v248, s[28:31], 0 offen sc1
    s_mov_b64 exec, -1
w0skip_37:
    s_cmp_eq_u32 s65, 3
    s_mov_b32 s71, 20480
    s_cselect_b32 s71, 18432, s71
    s_add_u32 s71, s70, s71
    buffer_load_dwordx4 v[184:187], v19, s[28:31], s71 offen offset:0
    buffer_load_dwordx4 v[188:191], v19, s[28:31], s71 offen offset:1024
    s_cmp_eq_u32 s65, 3
    s_mov_b32 s71, 327680
    s_cselect_b32 s71, 294912, s71
    s_add_u32 m0, s68, 0
    s_add_u32 s67, s66, s71
    buffer_load_dwordx4 v240, s[40:43], s67 offen lds
    s_add_u32 m0, s68, 1024
    s_add_u32 s67, s66, s71
    s_add_u32 s67, s67, 8192
    buffer_load_dwordx4 v240, s[40:43], s67 offen lds
    s_mov_b32 s36, s18
    s_and_b32 s37, s19, 0xffff
    s_mov_b32 s38, 0x400
    s_mov_b32 s39, 0x20000
    buffer_load_dwordx4 v[30:33], v30, s[36:39], 0 offen
    ds_read_b64_tr_b16 v[56:57], v22 offset:16384
    ds_read_b64_tr_b16 v[58:59], v22 offset:17408
    ds_read_b64_tr_b16 v[60:61], v23 offset:16384
    ds_read_b64_tr_b16 v[62:63], v23 offset:17408
    ds_read_b64_tr_b16 v[64:65], v22 offset:18432
    ds_read_b64_tr_b16 v[66:67], v22 offset:19456
    ds_read_b64_tr_b16 v[68:69], v23 offset:18432
    ds_read_b64_tr_b16 v[70:71], v23 offset:19456
    ds_read_b64_tr_b16 v[48:49], v22 offset:32768
    ds_read_b64_tr_b16 v[50:51], v22 offset:33792
    ds_read_b64_tr_b16 v[52:53], v23 offset:32768
    ds_read_b64_tr_b16 v[54:55], v23 offset:33792
    s_waitcnt lgkmcnt(8)
    v_mfma_f32_32x32x16_bf16 v[72:87], v[56:59], v[212:215], v[72:87]
    v_mfma_f32_32x32x16_bf16 v[88:103], v[60:63], v[212:215], v[88:103]
    ds_read_b64_tr_b16 v[56:57], v22 offset:34816
    ds_read_b64_tr_b16 v[58:59], v22 offset:35840
    ds_read_b64_tr_b16 v[60:61], v23 offset:34816
    ds_read_b64_tr_b16 v[62:63], v23 offset:35840
    s_waitcnt lgkmcnt(8)
    v_mfma_f32_32x32x16_bf16 v[72:87], v[64:67], v[216:219], v[72:87]
    v_mfma_f32_32x32x16_bf16 v[88:103], v[68:71], v[216:219], v[88:103]
    s_waitcnt lgkmcnt(4)
    v_mfma_f32_32x32x16_bf16 v[72:87], v[48:51], v[220:223], v[72:87]
    v_mfma_f32_32x32x16_bf16 v[88:103], v[52:55], v[220:223], v[88:103]
    s_waitcnt lgkmcnt(0)
    v_mfma_f32_32x32x16_bf16 v[72:87], v[56:59], v[224:227], v[72:87]
    v_mfma_f32_32x32x16_bf16 v[88:103], v[60:63], v[224:227], v[88:103]
    s_waitcnt vmcnt(7)
    s_barrier
    ds_read_b64_tr_b16 v[64:65], v22 offset:49152
    ds_read_b64_tr_b16 v[66:67], v22 offset:50176
    ds_read_b64_tr_b16 v[68:69], v23 offset:49152
    ds_read_b64_tr_b16 v[70:71], v23 offset:50176
    ds_read_b64_tr_b16 v[48:49], v22 offset:51200
    ds_read_b64_tr_b16 v[50:51], v22 offset:52224
    ds_read_b64_tr_b16 v[52:53], v23 offset:51200
    ds_read_b64_tr_b16 v[54:55], v23 offset:52224
    ds_read_b64_tr_b16 v[56:57], v24 offset:0
    ds_read_b64_tr_b16 v[58:59], v24 offset:1024
    ds_read_b64_tr_b16 v[60:61], v25 offset:0
    ds_read_b64_tr_b16 v[62:63], v25 offset:1024
    s_waitcnt lgkmcnt(8)
    v_mfma_f32_32x32x16_bf16 v[72:87], v[64:67], v[160:163], v[72:87]
    v_mfma_f32_32x32x16_bf16 v[88:103], v[68:71], v[160:163], v[88:103]
    ds_read_b64_tr_b16 v[64:65], v24 offset:2048
    ds_read_b64_tr_b16 v[66:67], v24 offset:3072
    ds_read_b64_tr_b16 v[68:69], v25 offset:2048
    ds_read_b64_tr_b16 v[70:71], v25 offset:3072
    s_waitcnt lgkmcnt(8)
    v_mfma_f32_32x32x16_bf16 v[72:87], v[48:51], v[164:167], v[72:87]
    v_mfma_f32_32x32x16_bf16 v[88:103], v[52:55], v[164:167], v[88:103]
    ds_read_b64_tr_b16 v[48:49], v24 offset:16384
    ds_read_b64_tr_b16 v[50:51], v24 offset:17408
    ds_read_b64_tr_b16 v[52:53], v25 offset:16384
    ds_read_b64_tr_b16 v[54:55], v25 offset:17408
    s_waitcnt lgkmcnt(8)
    v_mfma_f32_32x32x16_bf16 v[72:87], v[56:59], v[168:171], v[72:87]
    v_mfma_f32_32x32x16_bf16 v[88:103], v[60:63], v[168:171], v[88:103]
    ds_read_b64_tr_b16 v[56:57], v24 offset:18432
    ds_read_b64_tr_b16 v[58:59], v24 offset:19456
    ds_read_b64_tr_b16 v[60:61], v25 offset:18432
    ds_read_b64_tr_b16 v[62:63], v25 offset:19456
    s_waitcnt lgkmcnt(8)
    v_mfma_f32_32x32x16_bf16 v[72:87], v[64:67], v[172:175], v[72:87]
    v_mfma_f32_32x32x16_bf16 v[88:103], v[68:71], v[172:175], v[88:103]
    s_waitcnt vmcnt(5)
    s_waitcnt lgkmcnt(4)
    v_mfma_f32_32x32x16_bf16 v[72:87], v[48:51], v[176:179], v[72:87]
    v_mfma_f32_32x32x16_bf16 v[88:103], v[52:55], v[176:179], v[88:103]
    s_waitcnt lgkmcnt(0)
    v_mfma_f32_32x32x16_bf16 v[72:87], v[56:59], v[180:183], v[72:87]
    v_mfma_f32_32x32x16_bf16 v[88:103], v[60:63], v[180:183], v[88:103]
    s_branch L_t3
L_idle:
    s_mov_b32 s40, s16
    s_and_b32 s41, s17, 0xffff
    s_mov_b32 s42, 0x158000
    s_mov_b32 s43, 0x20000
    s_cmp_lg_u32 s3, 0
    s_cbranch_scc1 w0skip_38
    s_mov_b32 s49, 65536
    v_mov_b32 v248, 0
    s_branch nld_41
nretry_39:
    v_readfirstlane_b32 s78, v250
    v_readfirstlane_b32 s79, v251
    s_cmp_lg_u32 s78, 0
    s_cbranch_scc1 nok_40
    s_sub_u32 s49, s49, 1
    s_cmp_eq_u32 s49, 0
    s_cbranch_scc1 nok_40
nld_41:
    buffer_load_dwordx2 v[250:251], v248, s[96:99], 0 offen sc1
    s_waitcnt vmcnt(0)
    s_branch nretry_39
nok_40:
w0skip_38:
    s_add_u32 m0, s68, 0
    s_add_u32 s67, s66, 0
    buffer_load_dwordx4 v240, s[40:43], s67 offen lds
    s_add_u32 m0, s68, 1024
    s_add_u32 s67, s66, 8192
    buffer_load_dwordx4 v240, s[40:43], s67 offen lds
    s_add_u32 m0, s68, 16384
    s_add_u32 s67, s66, 32768
    buffer_load_dwordx4 v240, s[40:43], s67 offen lds
    s_add_u32 m0, s68, 17408
    s_add_u32 s67, s66, 40960
    buffer_load_dwordx4 v240, s[40:43], s67 offen lds
    s_add_u32 m0, s68, 32768
    s_add_u32 s67, s66, 65536
    buffer_load_dwordx4 v240, s[40:43], s67 offen lds
    s_add_u32 m0, s68, 33792
    s_add_u32 s67, s66, 73728
    buffer_load_dwordx4 v240, s[40:43], s67 offen lds
    s_add_u32 m0, s68, 49152
    s_add_u32 s67, s66, 98304
    buffer_load_dwordx4 v240, s[40:43], s67 offen lds
    s_add_u32 m0, s68, 50176
    s_add_u32 s67, s66, 106496
    buffer_load_dwordx4 v240, s[40:43], s67 offen lds
    s_add_u32 m0, s68, 65536
    s_add_u32 s67, s66, 131072
    buffer_load_dwordx4 v240, s[40:43], s67 offen lds
    s_add_u32 m0, s68, 66560
    s_add_u32 s67, s66, 139264
    buffer_load_dwordx4 v240, s[40:43], s67 offen lds
    s_add_u32 m0, s68, 81920
    s_add_u32 s67, s66, 163840
    buffer_load_dwordx4 v240, s[40:43], s67 offen lds
    s_add_u32 m0, s68, 82944
    s_add_u32 s67, s66, 172032
    buffer_load_dwordx4 v240, s[40:43], s67 offen lds
    s_add_u32 m0, s68, 98304
    s_add_u32 s67, s66, 196608
    buffer_load_dwordx4 v240, s[40:43], s67 offen lds
    s_add_u32 m0, s68, 99328
    s_add_u32 s67, s66, 204800
    buffer_load_dwordx4 v240, s[40:43], s67 offen lds
    s_add_u32 m0, s68, 114688
    s_add_u32 s67, s66, 229376
    buffer_load_dwordx4 v240, s[40:43], s67 offen lds
    s_add_u32 m0, s68, 115712
    s_add_u32 s67, s66, 237568
    buffer_load_dwordx4 v240, s[40:43], s67 offen lds
    s_add_u32 m0, s68, 131072
    s_add_u32 s67, s66, 262144
    buffer_load_dwordx4 v240, s[40:43], s67 offen lds
    s_add_u32 m0, s68, 132096
    s_add_u32 s67, s66, 270336
    buffer_load_dwordx4 v240, s[40:43], s67 offen lds
    s_add_u32 m0, s68, 147456
    s_add_u32 s67, s66, 294912
    buffer_load_dwordx4 v240, s[40:43], s67 offen lds
    s_add_u32 m0, s68, 148480
    s_add_u32 s67, s66, 303104
    buffer_load_dwordx4 v240, s[40:43], s67 offen lds
    v_bfe_u32 v2, v0, 2, 2
    v_lshrrev_b32 v3, 5, v0
    v_lshl_add_u32 v3, v3, 2, v2
    v_lshlrev_b32 v3, 7, v3
    v_bfe_u32 v4, v0, 4, 1
    v_and_b32 v5, 1, v0
    v_lshl_add_u32 v4, v4, 1, v5
    v_bfe_u32 v5, v0, 3, 1
    v_lshl_add_u32 v4, v5, 2, v4
    v_lshl_add_u32 v3, v4, 4, v3
    v_bfe_u32 v5, v0, 1, 1
    v_lshl_add_u32 v3, v5, 3, v3
    s_lshl_b32 s67, s65, 12
    v_add_u32 v20, s67, v3
    v_xor_b32 v21, 64, v20
    v_add_u32 v22, 65536, v20
    v_add_u32 v23, 65536, v21
    v_add_u32 v24, 131072, v20
    v_add_u32 v25, 131072, v21
    v_lshlrev_b32 v19, 4, v0
    s_mul_i32 s67, s64, 24576
    s_add_u32 s67, s67, 32768
    v_add_u32 v26, s67, v19
    s_mul_i32 s69, s65, 6144
    v_add_u32 v27, s69, v26
    s_lshl_b32 s69, s75, 6
    s_lshl_b32 s67, s64, 5
    s_add_u32 s69, s69, s67
    v_and_b32 v2, 31, v0
    v_add_u32 v2, s69, v2
    v_lshlrev_b32 v34, 2, v2
    v_lshlrev_b32 v3, 4, v2
    v_add_u32 v3, s74, v3
    v_cvt_f32_u32 v29, v3
    v_lshlrev_b32 v3, 10, v3
    v_lshrrev_b32 v4, 5, v0
    v_lshlrev_b32 v4, 4, v4
    s_lshl_b32 s67, s76, 7
    s_lshl_b32 s69, s65, 5
    s_add_u32 s67, s67, s69
    v_add_u32 v4, s67, v4
    v_add_u32 v28, v3, v4
    v_mov_b32 v30, v4
    s_mov_b32 s36, s18
    s_and_b32 s37, s19, 0xffff
    s_mov_b32 s38, 0x400
    s_mov_b32 s39, 0x20000
    buffer_load_dwordx4 v[30:33], v30, s[36:39], 0 offen
L_final:
    s_cmp_lg_u32 s3, 0
    s_cbranch_scc1 w0skip_42
    s_lshl_b32 s49, s74, 1
    s_add_u32 s49, s49, s75
    s_lshl_b32 s49, s49, 8
    s_add_u32 s49, s49, 12648448
    v_min_u32 v248, 14, v0
    v_lshlrev_b32 v248, 3, v248
    s_mov_b32 s48, 65536
poll_43:
    buffer_load_dwordx2 v[250:251], v248, s[28:31], s49 offen sc1
    s_waitcnt vmcnt(0)
    v_cmp_eq_u32 vcc, s78, v250
    v_cmp_eq_u32 s[50:51], s79, v251
    s_nop 0
    s_and_b64 vcc, vcc, s[50:51]
    s_cmp_eq_u64 vcc, exec
    s_cbranch_scc1 w0skip_42
    s_bcnt1_i32_b64 s50, vcc
    s_cmp_ge_u32 s50, 58
    s_cbranch_scc1 nobo_44
    s_sleep 16
nobo_44:
    s_sub_u32 s48, s48, 1
    s_cmp_lg_u32 s48, 0
    s_cbranch_scc1 poll_43
w0skip_42:
    s_barrier
    s_lshl_b32 s67, s74, 9
    s_add_u32 s67, s67, 10485760
    v_mov_b32 v2, v34
    buffer_load_dword v34, v2, s[28:31], s67 offen
    s_add_u32 s67, s67, 8192
    buffer_load_dword v35, v2, s[28:31], s67 offen
    s_add_u32 s67, s67, 8192
    buffer_load_dword v36, v2, s[28:31], s67 offen
    s_add_u32 s67, s67, 8192
    buffer_load_dword v37, v2, s[28:31], s67 offen
    s_mul_i32 s70, s74, 352256
    s_lshl_b32 s71, s75, 1
    s_add_u32 s71, s71, s64
    s_mul_i32 s71, s71, 88064
    s_add_u32 s70, s70, s71
    s_mul_i32 s71, s65, 22528
    s_add_u32 s70, s70, s71
    s_add_u32 s71, s70, 0
    buffer_load_dwordx4 v[104:107], v19, s[28:31], s71 offen offset:0
    buffer_load_dwordx4 v[108:111], v19, s[28:31], s71 offen offset:1024
    s_add_u32 s71, s70, 2048
    buffer_load_dwordx4 v[112:115], v19, s[28:31], s71 offen offset:0
    buffer_load_dwordx4 v[116:119], v19, s[28:31], s71 offen offset:1024
    s_add_u32 s71, s70, 4096
    buffer_load_dwordx4 v[120:123], v19, s[28:31], s71 offen offset:0
    buffer_load_dwordx4 v[124:127], v19, s[28:31], s71 offen offset:1024
    s_add_u32 s71, s70, 6144
    buffer_load_dwordx4 v[128:131], v19, s[28:31], s71 offen offset:0
    buffer_load_dwordx4 v[132:135], v19, s[28:31], s71 offen offset:1024
    s_add_u32 s71, s70, 8192
    buffer_load_dwordx4 v[136:139], v19, s[28:31], s71 offen offset:0
    buffer_load_dwordx4 v[140:143], v19, s[28:31], s71 offen offset:1024
    s_add_u32 s71, s70, 10240
    buffer_load_dwordx4 v[144:147], v19, s[28:31], s71 offen offset:0
    buffer_load_dwordx4 v[148:151], v19, s[28:31], s71 offen offset:1024
    s_add_u32 s71, s70, 12288
    buffer_load_dwordx4 v[152:155], v19, s[28:31], s71 offen offset:0
    buffer_load_dwordx4 v[156:159], v19, s[28:31], s71 offen offset:1024
    s_add_u32 s71, s70, 14336
    buffer_load_dwordx4 v[160:163], v19, s[28:31], s71 offen offset:0
    buffer_load_dwordx4 v[164:167], v19, s[28:31], s71 offen offset:1024
    s_add_u32 s71, s70, 16384
    buffer_load_dwordx4 v[168:171], v19, s[28:31], s71 offen offset:0
    buffer_load_dwordx4 v[172:175], v19, s[28:31], s71 offen offset:1024
    s_add_u32 s71, s70, 18432
    buffer_load_dwordx4 v[176:179], v19, s[28:31], s71 offen offset:0
    buffer_load_dwordx4 v[180:183], v19, s[28:31], s71 offen offset:1024
    s_cmp_eq_u32 s65, 3
    s_mov_b32 s71, 20480
    s_cselect_b32 s71, 18432, s71
    s_add_u32 s71, s70, s71
    buffer_load_dwordx4 v[184:187], v19, s[28:31], s71 offen offset:0
    buffer_load_dwordx4 v[188:191], v19, s[28:31], s71 offen offset:1024
    s_waitcnt vmcnt(22)
    v_add_f32 v34, v34, v35
    v_add_f32 v36, v36, v37
    v_add_f32 v34, v34, v36
    v_mul_f32 v34, 0xbfb8aa3b, v34
    v_exp_f32 v34, v34
    s_nop 0
    v_add_f32 v34, 1.0, v34
    v_rcp_f32 v16, v34
    s_nop 0
    v_sub_f32 v17, 1.0, v16
    v_mul_f32 v2, 0x3a000000, v29
    v_lshrrev_b32 v3, 5, v0
    v_lshlrev_b32 v3, 1, v3
    s_lshl_b32 s67, s65, 4
    v_add_u32 v3, s67, v3
    v_cvt_f32_u32 v3, v3
    v_mul_f32 v3, v3, v2
    v_sub_f32 v4, 0, v16
    v_mov_b32 v6, v3
    v_fmamk_f32 v7, v2, 0x3f800000, v3
    v_fmamk_f32 v8, v2, 0x40800000, v3
    v_fmamk_f32 v9, v2, 0x40a00000, v3
    v_fmamk_f32 v10, v2, 0x41000000, v3
    v_fmamk_f32 v11, v2, 0x41100000, v3
    v_fmamk_f32 v12, v2, 0x41400000, v3
    v_fmamk_f32 v13, v2, 0x41500000, v3
    v_cos_f32 v192, v6
    v_cos_f32 v193, v7
    v_cos_f32 v194, v8
    v_cos_f32 v195, v9
    v_cos_f32 v196, v10
    v_cos_f32 v197, v11
    v_cos_f32 v198, v12
    v_cos_f32 v199, v13
    v_sin_f32 v200, v6
    v_sin_f32 v201, v7
    v_sin_f32 v202, v8
    v_sin_f32 v203, v9
    v_sin_f32 v204, v10
    v_sin_f32 v205, v11
    v_sin_f32 v206, v12
    v_sin_f32 v207, v13
    v_mul_f32 v192, v16, v192
    v_mul_f32 v193, v16, v193
    v_mul_f32 v194, v16, v194
    v_mul_f32 v195, v16, v195
    v_mul_f32 v196, v16, v196
    v_mul_f32 v197, v16, v197
    v_mul_f32 v198, v16, v198
    v_mul_f32 v199, v16, v199
    v_mul_f32 v200, v4, v200
    v_mul_f32 v201, v4, v201
    v_mul_f32 v202, v4, v202
    v_mul_f32 v203, v4, v203
    v_mul_f32 v204, v4, v204
    v_mul_f32 v205, v4, v205
    v_mul_f32 v206, v4, v206
    v_mul_f32 v207, v4, v207
    s_cmp_lg_u32 s65, 0
    s_cbranch_scc1 nosp_45
    v_lshlrev_b32 v5, 31, v0
    v_xor_b32 v5, v5, v16
    v_cmp_gt_u32 vcc, 32, v0
    s_nop 1
    v_cndmask_b32 v200, v200, v5, vcc
nosp_45:
    v_cvt_pk_bf16_f32 v40, v192, v200
    v_cvt_pk_bf16_f32 v41, v193, v201
    v_cvt_pk_bf16_f32 v42, v194, v202
    v_cvt_pk_bf16_f32 v43, v195, v203
    v_cvt_pk_bf16_f32 v44, v196, v204
    v_cvt_pk_bf16_f32 v45, v197, v205
    v_cvt_pk_bf16_f32 v46, v198, v206
    v_cvt_pk_bf16_f32 v47, v199, v207
    s_barrier
    ds_read_b64_tr_b16 v[48:49], v20 offset:0
    ds_read_b64_tr_b16 v[50:51], v20 offset:1024
    ds_read_b64_tr_b16 v[52:53], v21 offset:0
    ds_read_b64_tr_b16 v[54:55], v21 offset:1024
    ds_read_b64_tr_b16 v[56:57], v20 offset:2048
    ds_read_b64_tr_b16 v[58:59], v20 offset:3072
    ds_read_b64_tr_b16 v[60:61], v21 offset:2048
    ds_read_b64_tr_b16 v[62:63], v21 offset:3072
    ds_read_b64_tr_b16 v[64:65], v20 offset:16384
    ds_read_b64_tr_b16 v[66:67], v20 offset:17408
    ds_read_b64_tr_b16 v[68:69], v21 offset:16384
    ds_read_b64_tr_b16 v[70:71], v21 offset:17408
    s_waitcnt vmcnt(20)
    s_waitcnt lgkmcnt(8)
    v_mfma_f32_32x32x16_bf16 v[72:87], v[48:51], v[104:107], 0
    v_mfma_f32_32x32x16_bf16 v[88:103], v[52:55], v[104:107], 0
    ds_read_b64_tr_b16 v[48:49], v20 offset:18432
    ds_read_b64_tr_b16 v[50:51], v20 offset:19456
    ds_read_b64_tr_b16 v[52:53], v21 offset:18432
    ds_read_b64_tr_b16 v[54:55], v21 offset:19456
    s_waitcnt lgkmcnt(8)
    v_mfma_f32_32x32x16_bf16 v[72:87], v[56:59], v[108:111], v[72:87]
    v_mfma_f32_32x32x16_bf16 v[88:103], v[60:63], v[108:111], v[88:103]
    s_waitcnt vmcnt(18)
    s_waitcnt lgkmcnt(4)
    v_mfma_f32_32x32x16_bf16 v[72:87], v[64:67], v[112:115], v[72:87]
    v_mfma_f32_32x32x16_bf16 v[88:103], v[68:71], v[112:115], v[88:103]
    s_waitcnt lgkmcnt(0)
    v_mfma_f32_32x32x16_bf16 v[72:87], v[48:51], v[116:119], v[72:87]
    v_mfma_f32_32x32x16_bf16 v[88:103], v[52:55], v[116:119], v[88:103]
    s_barrier
    s_cmp_eq_u32 s65, 3
    s_mov_b32 s71, 327680
    s_cselect_b32 s71, 294912, s71
    s_add_u32 m0, s68, 0
    s_add_u32 s67, s66, s71
    buffer_load_dwordx4 v240, s[40:43], s67 offen lds
    s_add_u32 m0, s68, 1024
    s_add_u32 s67, s66, s71
    s_add_u32 s67, s67, 8192
    buffer_load_dwordx4 v240, s[40:43], s67 offen lds
    ds_read_b64_tr_b16 v[56:57], v20 offset:32768
    ds_read_b64_tr_b16 v[58:59], v20 offset:33792
    ds_read_b64_tr_b16 v[60:61], v21 offset:32768
    ds_read_b64_tr_b16 v[62:63], v21 offset:33792
    ds_read_b64_tr_b16 v[64:65], v20 offset:34816
    ds_read_b64_tr_b16 v[66:67], v20 offset:35840
    ds_read_b64_tr_b16 v[68:69], v21 offset:34816
    ds_read_b64_tr_b16 v[70:71], v21 offset:35840
    ds_read_b64_tr_b16 v[48:49], v20 offset:49152
    ds_read_b64_tr_b16 v[50:51], v20 offset:50176
    ds_read_b64_tr_b16 v[52:53], v21 offset:49152
    ds_read_b64_tr_b16 v[54:55], v21 offset:50176
    s_waitcnt vmcnt(18)
    s_waitcnt lgkmcnt(8)
    v_mfma_f32_32x32x16_bf16 v[72:87], v[56:59], v[120:123], v[72:87]
    v_mfma_f32_32x32x16_bf16 v[88:103], v[60:63], v[120:123], v[88:103]
    ds_read_b64_tr_b16 v[56:57], v20 offset:51200
    ds_read_b64_tr_b16 v[58:59], v20 offset:52224
    ds_read_b64_tr_b16 v[60:61], v21 offset:51200
    ds_read_b64_tr_b16 v[62:63], v21 offset:52224
    s_waitcnt lgkmcnt(8)
    v_mfma_f32_32x32x16_bf16 v[72:87], v[64:67], v[124:127], v[72:87]
    v_mfma_f32_32x32x16_bf16 v[88:103], v[68:71], v[124:127], v[88:103]
    ds_read_b64_tr_b16 v[64:65], v22 offset:0
    ds_read_b64_tr_b16 v[66:67], v22 offset:1024
    ds_read_b64_tr_b16 v[68:69], v23 offset:0
    ds_read_b64_tr_b16 v[70:71], v23 offset:1024
    s_waitcnt vmcnt(16)
    s_waitcnt lgkmcnt(8)
    v_mfma_f32_32x32x16_bf16 v[72:87], v[48:51], v[128:131], v[72:87]
    v_mfma_f32_32x32x16_bf16 v[88:103], v[52:55], v[128:131], v[88:103]
    ds_read_b64_tr_b16 v[48:49], v22 offset:2048
    ds_read_b64_tr_b16 v[50:51], v22 offset:3072
    ds_read_b64_tr_b16 v[52:53], v23 offset:2048
    ds_read_b64_tr_b16 v[54:55], v23 offset:3072
    s_waitcnt lgkmcnt(8)
    v_mfma_f32_32x32x16_bf16 v[72:87], v[56:59], v[132:135], v[72:87]
    v_mfma_f32_32x32x16_bf16 v[88:103], v[60:63], v[132:135], v[88:103]
    ds_read_b64_tr_b16 v[56:57], v22 offset:16384
    ds_read_b64_tr_b16 v[58:59], v22 offset:17408
    ds_read_b64_tr_b16 v[60:61], v23 offset:16384
    ds_read_b64_tr_b16 v[62:63], v23 offset:17408
    s_waitcnt vmcnt(14)
    s_waitcnt lgkmcnt(8)
    v_mfma_f32_32x32x16_bf16 v[72:87], v[64:67], v[136:139], v[72:87]
    v_mfma_f32_32x32x16_bf16 v[88:103], v[68:71], v[136:139], v[88:103]
    ds_read_b64_tr_b16 v[64:65], v22 offset:18432
    ds_read_b64_tr_b16 v[66:67], v22 offset:19456
    ds_read_b64_tr_b16 v[68:69], v23 offset:18432
    ds_read_b64_tr_b16 v[70:71], v23 offset:19456
    s_waitcnt lgkmcnt(8)
    v_mfma_f32_32x32x16_bf16 v[72:87], v[48:51], v[140:143], v[72:87]
    v_mfma_f32_32x32x16_bf16 v[88:103], v[52:55], v[140:143], v[88:103]
    ds_read_b64_tr_b16 v[48:49], v22 offset:32768
    ds_read_b64_tr_b16 v[50:51], v22 offset:33792
    ds_read_b64_tr_b16 v[52:53], v23 offset:32768
    ds_read_b64_tr_b16 v[54:55], v23 offset:33792
    s_waitcnt vmcnt(12)
    s_waitcnt lgkmcnt(8)
    v_mfma_f32_32x32x16_bf16 v[72:87], v[56:59], v[144:147], v[72:87]
    v_mfma_f32_32x32x16_bf16 v[88:103], v[60:63], v[144:147], v[88:103]
    ds_read_b64_tr_b16 v[56:57], v22 offset:34816
    ds_read_b64_tr_b16 v[58:59], v22 offset:35840
    ds_read_b64_tr_b16 v[60:61], v23 offset:34816
    ds_read_b64_tr_b16 v[62:63], v23 offset:35840
    s_waitcnt lgkmcnt(8)
    v_mfma_f32_32x32x16_bf16 v[72:87], v[64:67], v[148:151], v[72:87]
    v_mfma_f32_32x32x16_bf16 v[88:103], v[68:71], v[148:151], v[88:103]
    ds_read_b64_tr_b16 v[64:65], v22 offset:49152
    ds_read_b64_tr_b16 v[66:67], v22 offset:50176
    ds_read_b64_tr_b16 v[68:69], v23 offset:49152
    ds_read_b64_tr_b16 v[70:71], v23 offset:50176
    s_waitcnt vmcnt(10)
    s_waitcnt lgkmcnt(8)
    v_mfma_f32_32x32x16_bf16 v[72:87], v[48:51], v[152:155], v[72:87]
    v_mfma_f32_32x32x16_bf16 v[88:103], v[52:55], v[152:155], v[88:103]
    ds_read_b64_tr_b16 v[48:49], v22 offset:51200
    ds_read_b64_tr_b16 v[50:51], v22 offset:52224
    ds_read_b64_tr_b16 v[52:53], v23 offset:51200
    ds_read_b64_tr_b16 v[54:55], v23 offset:52224
    s_waitcnt lgkmcnt(8)
    v_mfma_f32_32x32x16_bf16 v[72:87], v[56:59], v[156:159], v[72:87]
    v_mfma_f32_32x32x16_bf16 v[88:103], v[60:63], v[156:159], v[88:103]
    ds_read_b64_tr_b16 v[56:57], v24 offset:0
    ds_read_b64_tr_b16 v[58:59], v24 offset:1024
    ds_read_b64_tr_b16 v[60:61], v25 offset:0
    ds_read_b64_tr_b16 v[62:63], v25 offset:1024
    s_waitcnt vmcnt(8)
    s_waitcnt lgkmcnt(8)
    v_mfma_f32_32x32x16_bf16 v[72:87], v[64:67], v[160:163], v[72:87]
    v_mfma_f32_32x32x16_bf16 v[88:103], v[68:71], v[160:163], v[88:103]
    ds_read_b64_tr_b16 v[64:65], v24 offset:2048
    ds_read_b64_tr_b16 v[66:67], v24 offset:3072
    ds_read_b64_tr_b16 v[68:69], v25 offset:2048
    ds_read_b64_tr_b16 v[70:71], v25 offset:3072
    s_waitcnt lgkmcnt(8)
    v_mfma_f32_32x32x16_bf16 v[72:87], v[48:51], v[164:167], v[72:87]
    v_mfma_f32_32x32x16_bf16 v[88:103], v[52:55], v[164:167], v[88:103]
    ds_read_b64_tr_b16 v[48:49], v24 offset:16384
    ds_read_b64_tr_b16 v[50:51], v24 offset:17408
    ds_read_b64_tr_b16 v[52:53], v25 offset:16384
    ds_read_b64_tr_b16 v[54:55], v25 offset:17408
    s_waitcnt vmcnt(6)
    s_waitcnt lgkmcnt(8)
    v_mfma_f32_32x32x16_bf16 v[72:87], v[56:59], v[168:171], v[72:87]
    v_mfma_f32_32x32x16_bf16 v[88:103], v[60:63], v[168:171], v[88:103]
    ds_read_b64_tr_b16 v[56:57], v24 offset:18432
    ds_read_b64_tr_b16 v[58:59], v24 offset:19456
    ds_read_b64_tr_b16 v[60:61], v25 offset:18432
    ds_read_b64_tr_b16 v[62:63], v25 offset:19456
    s_waitcnt lgkmcnt(8)
    v_mfma_f32_32x32x16_bf16 v[72:87], v[64:67], v[172:175], v[72:87]
    v_mfma_f32_32x32x16_bf16 v[88:103], v[68:71], v[172:175], v[88:103]
    s_waitcnt vmcnt(4)
    s_waitcnt lgkmcnt(4)
    v_mfma_f32_32x32x16_bf16 v[72:87], v[48:51], v[176:179], v[72:87]
    v_mfma_f32_32x32x16_bf16 v[88:103], v[52:55], v[176:179], v[88:103]
    s_waitcnt lgkmcnt(0)
    v_mfma_f32_32x32x16_bf16 v[72:87], v[56:59], v[180:183], v[72:87]
    v_mfma_f32_32x32x16_bf16 v[88:103], v[60:63], v[180:183], v[88:103]
L_t3:
    s_cmp_lg_u32 s3, 0
    s_cbranch_scc1 w0skip_46
    s_and_b32 s49, s2, 31
    s_lshl_b32 s49, s49, 10
    s_add_u32 s49, s49, 12599296
    v_lshlrev_b32 v248, 3, v0
    v_mov_b32 v249, 0
    s_mov_b32 s48, 65536
poll_47:
    buffer_load_dwordx2 v[250:251], v248, s[28:31], s49 offen sc1
    buffer_load_dwordx2 v[252:253], v249, s[28:31], s49 offen offset:512 sc1
    s_waitcnt vmcnt(0)
    v_cmp_eq_u32 vcc, s78, v250
    v_cmp_eq_u32 s[50:51], s79, v251
    s_nop 0
    s_and_b64 vcc, vcc, s[50:51]
    v_cmp_eq_u32 s[50:51], s78, v252
    s_nop 0
    s_and_b64 vcc, vcc, s[50:51]
    v_cmp_eq_u32 s[50:51], s79, v253
    s_nop 0
    s_and_b64 vcc, vcc, s[50:51]
    s_cmp_eq_u64 vcc, exec
    s_cbranch_scc1 w0skip_46
    s_bcnt1_i32_b64 s50, vcc
    s_cmp_ge_u32 s50, 56
    s_cbranch_scc1 nobo_48
    s_sleep 10
    s_cmp_ge_u32 s50, 32
    s_cbranch_scc1 nobo_48
    s_sleep 16
nobo_48:
    s_sub_u32 s48, s48, 1
    s_cmp_lg_u32 s48, 0
    s_cbranch_scc1 poll_47
w0skip_46:
    s_barrier
    s_waitcnt vmcnt(0)
    s_barrier
    s_lshl_b32 s70, s74, 17
    s_lshl_b32 s71, s65, 15
    s_add_u32 s70, s70, s71
    s_lshl_b32 s71, s64, 14
    s_add_u32 s70, s70, s71
    s_lshl_b32 s71, s76, 7
    s_add_u32 s70, s70, s71
    s_add_u32 s70, s70, 8388608
    s_add_u32 m0, s68, 16384
    s_add_u32 s67, s70, 0
    buffer_load_dwordx4 v240, s[28:31], s67 offen lds
    s_add_u32 m0, s68, 17408
    s_add_u32 s67, s70, 8192
    buffer_load_dwordx4 v240, s[28:31], s67 offen lds
    s_cmp_eq_u32 s65, 3
    s_cbranch_scc1 no10_49
    ds_read_b64_tr_b16 v[64:65], v20 offset:0
    ds_read_b64_tr_b16 v[66:67], v20 offset:1024
    ds_read_b64_tr_b16 v[68:69], v21 offset:0
    ds_read_b64_tr_b16 v[70:71], v21 offset:1024
    ds_read_b64_tr_b16 v[48:49], v20 offset:2048
    ds_read_b64_tr_b16 v[50:51], v20 offset:3072
    ds_read_b64_tr_b16 v[52:53], v21 offset:2048
    ds_read_b64_tr_b16 v[54:55], v21 offset:3072
    s_waitcnt lgkmcnt(4)
    v_mfma_f32_32x32x16_bf16 v[72:87], v[64:67], v[184:187], v[72:87]
    v_mfma_f32_32x32x16_bf16 v[88:103], v[68:71], v[184:187], v[88:103]
    s_waitcnt lgkmcnt(0)
    v_mfma_f32_32x32x16_bf16 v[72:87], v[48:51], v[188:191], v[72:87]
    v_mfma_f32_32x32x16_bf16 v[88:103], v[52:55], v[188:191], v[88:103]
no10_49:
    s_nop 10
    v_mul_f32 v72, v17, v72
    v_mul_f32 v73, v17, v73
    v_mul_f32 v74, v17, v74
    v_mul_f32 v75, v17, v75
    v_mul_f32 v76, v17, v76
    v_mul_f32 v77, v17, v77
    v_mul_f32 v78, v17, v78
    v_mul_f32 v79, v17, v79
    v_mul_f32 v80, v17, v80
    v_mul_f32 v81, v17, v81
    v_mul_f32 v82, v17, v82
    v_mul_f32 v83, v17, v83
    v_mul_f32 v84, v17, v84
    v_mul_f32 v85, v17, v85
    v_mul_f32 v86, v17, v86
    v_mul_f32 v87, v17, v87
    v_mul_f32 v88, v17, v88
    v_mul_f32 v89, v17, v89
    v_mul_f32 v90, v17, v90
    v_mul_f32 v91, v17, v91
    v_mul_f32 v92, v17, v92
    v_mul_f32 v93, v17, v93
    v_mul_f32 v94, v17, v94
    v_mul_f32 v95, v17, v95
    v_mul_f32 v96, v17, v96
    v_mul_f32 v97, v17, v97
    v_mul_f32 v98, v17, v98
    v_mul_f32 v99, v17, v99
    v_mul_f32 v100, v17, v100
    v_mul_f32 v101, v17, v101
    v_mul_f32 v102, v17, v102
    v_mul_f32 v103, v17, v103
    s_waitcnt vmcnt(0)
    s_barrier
    ds_read_b64_tr_b16 v[56:57], v20 offset:16384
    ds_read_b64_tr_b16 v[58:59], v20 offset:17408
    ds_read_b64_tr_b16 v[60:61], v21 offset:16384
    ds_read_b64_tr_b16 v[62:63], v21 offset:17408
    ds_read_b64_tr_b16 v[64:65], v20 offset:18432
    ds_read_b64_tr_b16 v[66:67], v20 offset:19456
    ds_read_b64_tr_b16 v[68:69], v21 offset:18432
    ds_read_b64_tr_b16 v[70:71], v21 offset:19456
    s_waitcnt lgkmcnt(4)
    v_mfma_f32_32x32x16_bf16 v[72:87], v[56:59], v[40:43], v[72:87]
    v_mfma_f32_32x32x16_bf16 v[88:103], v[60:63], v[40:43], v[88:103]
    s_waitcnt lgkmcnt(0)
    v_mfma_f32_32x32x16_bf16 v[72:87], v[64:67], v[44:47], v[72:87]
    v_mfma_f32_32x32x16_bf16 v[88:103], v[68:71], v[44:47], v[88:103]
    s_cmp_lg_u32 s65, 0
    s_cbranch_scc1 red_51
    s_nop 8
    ds_write_b128 v26, v[80:83] offset:6144
    ds_write_b128 v26, v[84:87] offset:7168
    ds_write_b128 v26, v[88:91] offset:14336
    ds_write_b128 v26, v[92:95] offset:15360
    ds_write_b128 v26, v[96:99] offset:22528
    ds_write_b128 v26, v[100:103] offset:23552
    v_mov_b32 v48, v72
    v_mov_b32 v49, v73
    v_mov_b32 v50, v74
    v_mov_b32 v51, v75
    v_mov_b32 v52, v76
    v_mov_b32 v53, v77
    v_mov_b32 v54, v78
    v_mov_b32 v55, v79
    s_branch redj_54
red_51:
    s_cmp_lg_u32 s65, 1
    s_cbranch_scc1 red_52
    s_nop 6
    ds_write_b128 v26, v[72:75] offset:0
    ds_write_b128 v26, v[76:79] offset:1024
    ds_write_b128 v26, v[96:99] offset:20480
    ds_write_b128 v26, v[100:103] offset:21504
    ds_write_b128 v26, v[88:91] offset:16384
    ds_write_b128 v26, v[92:95] offset:17408
    v_mov_b32 v48, v80
    v_mov_b32 v49, v81
    v_mov_b32 v50, v82
    v_mov_b32 v51, v83
    v_mov_b32 v52, v84
    v_mov_b32 v53, v85
    v_mov_b32 v54, v86
    v_mov_b32 v55, v87
    s_branch redj_54
red_52:
    s_cmp_lg_u32 s65, 2
    s_cbranch_scc1 red_53
    s_nop 5
    ds_write_b128 v26, v[96:99] offset:18432
    ds_write_b128 v26, v[100:103] offset:19456
    ds_write_b128 v26, v[72:75] offset:2048
    ds_write_b128 v26, v[76:79] offset:3072
    ds_write_b128 v26, v[80:83] offset:10240
    ds_write_b128 v26, v[84:87] offset:11264
    v_mov_b32 v48, v88
    v_mov_b32 v49, v89
    v_mov_b32 v50, v90
    v_mov_b32 v51, v91
    v_mov_b32 v52, v92
    v_mov_b32 v53, v93
    v_mov_b32 v54, v94
    v_mov_b32 v55, v95
    s_branch redj_54
red_53:
    s_nop 5
    ds_write_b128 v26, v[88:91] offset:12288
    ds_write_b128 v26, v[92:95] offset:13312
    ds_write_b128 v26, v[80:83] offset:8192
    ds_write_b128 v26, v[84:87] offset:9216
    ds_write_b128 v26, v[72:75] offset:4096
    ds_write_b128 v26, v[76:79] offset:5120
    v_mov_b32 v48, v96
    v_mov_b32 v49, v97
    v_mov_b32 v50, v98
    v_mov_b32 v51, v99
    v_mov_b32 v52, v100
    v_mov_b32 v53, v101
    v_mov_b32 v54, v102
    v_mov_b32 v55, v103
redj_54:
    s_waitcnt lgkmcnt(0)
    s_barrier
    ds_read_b128 v[192:195], v27 offset:0
    ds_read_b128 v[196:199], v27 offset:1024
    ds_read_b128 v[200:203], v27 offset:2048
    ds_read_b128 v[204:207], v27 offset:3072
    ds_read_b128 v[208:211], v27 offset:4096
    ds_read_b128 v[212:215], v27 offset:5120
    v_lshlrev_b32 v104, 16, v30
    v_and_b32 v105, 0xffff0000, v30
    v_lshlrev_b32 v106, 16, v31
    v_and_b32 v107, 0xffff0000, v31
    v_lshlrev_b32 v108, 16, v32
    v_and_b32 v109, 0xffff0000, v32
    v_lshlrev_b32 v110, 16, v33
    v_and_b32 v111, 0xffff0000, v33
    v_fmac_f32 v48, v17, v104
    v_fmac_f32 v49, v17, v105
    v_fmac_f32 v50, v17, v106
    v_fmac_f32 v51, v17, v107
    v_fmac_f32 v52, v17, v108
    v_fmac_f32 v53, v17, v109
    v_fmac_f32 v54, v17, v110
    v_fmac_f32 v55, v17, v111
    s_waitcnt lgkmcnt(4)
    v_add_f32 v48, v48, v192
    v_add_f32 v49, v49, v193
    v_add_f32 v50, v50, v194
    v_add_f32 v51, v51, v195
    v_add_f32 v52, v52, v196
    v_add_f32 v53, v53, v197
    v_add_f32 v54, v54, v198
    v_add_f32 v55, v55, v199
    s_waitcnt lgkmcnt(2)
    v_add_f32 v48, v48, v200
    v_add_f32 v49, v49, v201
    v_add_f32 v50, v50, v202
    v_add_f32 v51, v51, v203
    v_add_f32 v52, v52, v204
    v_add_f32 v53, v53, v205
    v_add_f32 v54, v54, v206
    v_add_f32 v55, v55, v207
    s_waitcnt lgkmcnt(0)
    v_add_f32 v48, v48, v208
    v_add_f32 v49, v49, v209
    v_add_f32 v50, v50, v210
    v_add_f32 v51, v51, v211
    v_add_f32 v52, v52, v212
    v_add_f32 v53, v53, v213
    v_add_f32 v54, v54, v214
    v_add_f32 v55, v55, v215
    v_cvt_pk_bf16_f32 v192, v48, v49
    v_cvt_pk_bf16_f32 v193, v50, v51
    v_cvt_pk_bf16_f32 v194, v52, v53
    v_cvt_pk_bf16_f32 v195, v54, v55
    s_mov_b32 s36, s22
    s_and_b32 s37, s23, 0xffff
    s_mov_b32 s38, 0x200000
    s_mov_b32 s39, 0x20000
    buffer_store_dwordx4 v[192:195], v28, s[36:39], 0 offen
L_end:
    s_endpgm
.section .rodata,"a"
.p2align 6
.amdhsa_kernel gated_mix__spectral_gfnet__dense_activation_gelu__prompt_kernel
  .amdhsa_next_free_vgpr 254
  .amdhsa_next_free_sgpr 101
  .amdhsa_accum_offset 256
  .amdhsa_group_segment_fixed_size 0
  .amdhsa_kernarg_size 96
  .amdhsa_user_sgpr_count 2
  .amdhsa_user_sgpr_kernarg_segment_ptr 1
  .amdhsa_system_sgpr_workgroup_id_x 1
.end_amdhsa_kernel
```
